```python
import torch

def _softmax(x, axis=-1):
    return torch.softmax(x, dim=axis)
def _gelu(x):
    return torch.nn.functional.gelu(x, approximate="tanh")
def _silu(x):
    return torch.nn.functional.silu(x)
def _sigmoid(x):
    return torch.sigmoid(x)
def _layernorm(x, axis=-1, eps=1e-5):
    m = x.mean(dim=axis, keepdim=True)
    v = x.var(dim=axis, keepdim=True, unbiased=False)
    return (x - m) / torch.sqrt(v + eps)
def _scatter_add(tgt, idx, src, axis=0):
    return tgt.clone().index_add_(axis, idx, src)
def _segment_sum(src, seg, n):
    out = torch.zeros((n,) + src.shape[1:], dtype=src.dtype)
    return out.index_add_(0, seg, src)
def _pad(x, pw):
    flat = tuple(v for pair in reversed(pw) for v in pair)
    return torch.nn.functional.pad(x, flat)

kernel_name = 'gated_mix__grouped_kv_mqa__sliding_block__prompt'

def setup_inputs():

    _w = (lambda a: (lambda t: t.to(torch.bfloat16) if t.is_floating_point() else t)(torch.as_tensor(a)))
    def _A_setup():
        B, S, D, H = 1, 2048, 640, 32
        Dh = D // H
        return {
            "x": _w((lambda *s: torch.randn(*s, dtype=torch.bfloat16) * 0.05)(B, S, D)),
            "wq": _w((lambda *s: torch.randn(*s, dtype=torch.bfloat16) * 3.2)(D, H * Dh)),
            "wk": _w((lambda *s: torch.randn(*s, dtype=torch.bfloat16) * 3.2)(D, Dh)),
            "wv": _w((lambda *s: torch.randn(*s, dtype=torch.bfloat16) * 0.4)(D, Dh)),
            "wo": _w((lambda *s: torch.randn(*s, dtype=torch.bfloat16) * 0.4)(H * Dh, D)),
        }
    _A_in = _A_setup()

    def _B_setup():
        B, S, D = 1, 2048, 640
        return {
            "x": _w((lambda *s: torch.randn(*s, dtype=torch.bfloat16) * 0.05)(B, S, D)),
            "wqkv": _w((lambda *s: torch.randn(*s, dtype=torch.bfloat16) * 1.6)(D, 3 * D)),
            "wo": _w((lambda *s: torch.randn(*s, dtype=torch.bfloat16) * 0.4)(D, D)),
        }
    _B_in = _B_setup()

    return {
        "A_x": _A_in["x"],
        "A_wq": _A_in["wq"],
        "A_wk": _A_in["wk"],
        "A_wv": _A_in["wv"],
        "A_wo": _A_in["wo"],
        "B_x": _B_in["x"],
        "B_wqkv": _B_in["wqkv"],
        "B_wo": _B_in["wo"],
        "gate_w": _w((lambda *s: torch.randn(*s, dtype=torch.bfloat16) * 0.8)(640) * 16.0),
    }

def reference(A_x, A_wq, A_wk, A_wv, A_wo, B_x, B_wqkv, B_wo, gate_w):
    def _A_ref(x, wq, wk, wv, wo):
        B, S, D = x.shape
        H = 32
        Dh = D // H
        q = (lambda x, *d: x.permute(*d))((x @ wq).reshape(B, S, H, Dh), 0, 2, 1, 3)
        k = x @ wk
        v = x @ wv
        scores = torch.einsum("bhqd,bkd->bhqk", q, k) * (Dh ** -0.5)
        p = _softmax(scores, axis=-1)
        o = torch.einsum("bhqk,bkd->bhqd", p, v)
        return (lambda x, *d: x.permute(*d))(o, 0, 2, 1, 3).reshape(B, S, H * Dh) @ wo

    def _B_ref(x, wqkv, wo):
        B, S, D = x.shape
        H = 32; Dh = D // H; W = 256
        qkv = (lambda x, *d: x.permute(*d))((x @ wqkv).reshape(B, S, 3, H, Dh), 2, 0, 3, 1, 4)
        q, k, v = qkv[0], qkv[1], qkv[2]
        scores = torch.einsum("bhqd,bhkd->bhqk", q, k) * (Dh ** -0.5)
        idx = torch.arange(S)
        mask = (idx[:, None] - idx[None, :] >= 0) & (idx[:, None] - idx[None, :] < W)
        scores = torch.where(mask[None, None], scores, -1e9)
        p = _softmax(scores, axis=-1)
        o = torch.einsum("bhqk,bhkd->bhqd", p, v)
        return (lambda x, *d: x.permute(*d))(o, 0, 2, 1, 3).reshape(B, S, D) @ wo

    x = A_x
    g = _sigmoid((x * gate_w).sum(-1, keepdims=True))
    a = _A_ref(x, A_wq, A_wk, A_wv, A_wo)
    b = _B_ref(x, B_wqkv, B_wo)
    return g * a + (1 - g) * b
```

```asm
; @launch kernel=k1_kernel grid=(256,1,1) block=(512,1,1) lds=156928
; @launch kernel=k2_kernel grid=(256,1,1) block=(576,1,1) lds=147456
; @launch kernel=k3_kernel grid=(256,1,1) block=(512,1,1) lds=147456
.amdgcn_target "amdgcn-amd-amdhsa--gfx950"
.text
  .globl k1_kernel
  .p2align 8
  .type k1_kernel,@function
k1_kernel:
  s_cmp_ge_u32 s2, 256
  s_cbranch_scc1 K1_END
  s_load_dwordx8 s[4:11], s[0:1], 0
  s_load_dwordx8 s[12:19], s[0:1], 32
  s_load_dwordx4 s[20:23], s[0:1], 64
  s_load_dwordx4 s[24:27], s[0:1], 80
  v_lshrrev_b32 v2, 6, v0
  v_and_b32 v1, 63, v0
  s_nop 0
  v_readfirstlane_b32 s48, v2
  s_and_b32 s52, s2, 7
  s_lshr_b32 s53, s2, 3
  s_and_b32 s49, s52, 1
  s_lshl_b32 s49, s49, 3
  s_and_b32 s51, s53, 7
  s_add_u32 s49, s49, s51
  s_lshr_b32 s50, s52, 1
  s_lshl_b32 s50, s50, 2
  s_lshr_b32 s53, s53, 3
  s_add_u32 s50, s50, s53
  s_cmp_lt_u32 s50, 4
  s_mov_b32 s56, 3840
  s_cselect_b32 s51, 1280, s56
  s_cselect_b32 s57, 0, 4
  s_sub_u32 s57, s50, s57
  s_mul_i32 s57, s57, 320
  s_mul_i32 s58, s49, 163840
  s_mul_i32 s59, s51, 640
  s_sub_u32 s59, s59, s57
  s_cmp_ge_u32 s48, 4
  s_cbranch_scc1 K1_LOADER
  s_lshr_b32 s60, s48, 1
  s_and_b32 s61, s48, 1
  s_lshr_b32 s62, s2, 3
  s_lshr_b32 s76, s62, 3
  s_and_b32 s62, s62, 7
  s_mul_i32 s77, s48, 80
  v_add_u32 v17, s77, v1
  v_lshlrev_b32 v17, 7, v17
  s_mul_i32 s76, s76, 40960
  v_min_u32 v18, 15, v1
  v_add_u32 v18, s77, v18
  v_add_u32 v18, 64, v18
  v_lshlrev_b32 v18, 7, v18
  s_lshl_b32 s77, s48, 6
  v_add_u32 v20, s77, v1
  v_mul_u32_u24 v19, 0x5556, v20
  v_lshrrev_b32 v19, 16, v19
  v_mul_u32_u24 v21, 3, v19
  v_sub_u32 v21, v20, v21
  v_min_u32 v19, 79, v19
  v_mul_lo_u32 v19, v19, s51
  v_lshl_add_u32 v19, v21, 7, v19
  s_mul_i32 s77, s62, 80
  s_mul_i32 s77, s77, s51
  s_and_b32 s79, s49, 7
  s_lshl_b32 s79, s79, 1
  s_and_b32 s75, s50, 1
  s_add_u32 s79, s79, s75
  s_mul_i32 s79, s79, 13
  v_min_u32 v21, 12, v1
  v_add_u32 v21, s79, v21
  v_min_u32 v21, 199, v21
  v_lshlrev_b32 v21, 7, v21
  s_waitcnt lgkmcnt(0)
  s_add_u32 s28, s4, s58
  s_addc_u32 s29, s5, 0
  s_and_b32 s29, s29, 0xffff
  s_mov_b32 s30, 163840
  s_mov_b32 s31, 0x20000
  buffer_load_dword v22, v17, s[28:31], s76 offen
  buffer_load_dword v22, v18, s[28:31], s76 offen
  s_cmp_lt_u32 s50, 4
  s_cselect_b32 s54, s6, s16
  s_cselect_b32 s55, s7, s17
  s_add_u32 s32, s54, s57
  s_addc_u32 s33, s55, 0
  s_and_b32 s33, s33, 0xffff
  s_mov_b32 s34, s59
  s_mov_b32 s35, 0x20000
  buffer_load_dword v22, v19, s[32:35], s77 offen
  s_and_b32 s55, s50, 3
  s_cmp_lt_u32 s55, 2
  s_cselect_b32 s52, s8, s10
  s_cselect_b32 s53, s9, s11
  s_and_b32 s56, s50, 1
  s_lshl_b32 s56, s56, 5
  s_sub_u32 s55, 25600, s56
  s_add_u32 s36, s52, s56
  s_addc_u32 s37, s53, 0
  s_and_b32 s37, s37, 0xffff
  s_mov_b32 s38, s55
  s_mov_b32 s39, 0x20000
  buffer_load_dword v22, v21, s[36:39], 0 offen
  s_mov_b32 s40, s26
  s_and_b32 s41, s27, 0xffff
  s_mov_b32 s42, 16777216
  s_mov_b32 s43, 0x20000
  s_mov_b32 s44, s20
  s_and_b32 s45, s21, 0xffff
  s_mov_b32 s46, 1280
  s_mov_b32 s47, 0x20000
  v_and_b32 v2, 15, v1
  v_lshrrev_b32 v3, 4, v1
  v_lshrrev_b32 v4, 2, v2
  v_and_b32 v5, 3, v1
  s_lshl_b32 s62, s60, 13
  v_lshlrev_b32 v6, 7, v2
  v_add_u32 v6, s62, v6
  v_and_b32 v17, 7, v2
  v_xor_b32 v17, v17, v3
  v_lshlrev_b32 v17, 4, v17
  v_add_u32 v6, v6, v17
  v_xor_b32 v7, 64, v6
  v_lshl_add_u32 v17, v3, 3, v4
  v_mul_u32_u24 v18, 320, v17
  v_lshl_add_u32 v18, v5, 3, v18
  s_mul_i32 s62, s61, 160
  s_add_u32 s62, s62, 16384
  v_add_u32 v18, s62, v18
  v_and_b32 v19, 1, v3
  v_lshlrev_b32 v19, 5, v19
  v_add_u32 v20, v18, v19
  v_sub_u32 v21, v18, v19
  s_cmp_eq_u32 s61, 0
  s_cselect_b64 vcc, -1, 0
  v_cndmask_b32 v8, v21, v20, vcc
  v_cndmask_b32 v9, v20, v21, vcc
  v_lshlrev_b32 v10, 5, v17
  v_lshl_add_u32 v10, v5, 3, v10
  v_add_u32 v10, 36864, v10
  v_lshlrev_b32 v11, 4, v3
  v_add_u32 v11, 155648, v11
  v_mov_b32 v24, 0
  v_mov_b32 v25, 0
  v_mov_b32 v26, 0
  v_mov_b32 v27, 0
  v_mov_b32 v28, 0
  v_mov_b32 v29, 0
  v_mov_b32 v30, 0
  v_mov_b32 v31, 0
  v_mov_b32 v32, 0
  v_mov_b32 v33, 0
  v_mov_b32 v34, 0
  v_mov_b32 v35, 0
  v_mov_b32 v36, 0
  v_mov_b32 v37, 0
  v_mov_b32 v38, 0
  v_mov_b32 v39, 0
  v_mov_b32 v40, 0
  v_mov_b32 v41, 0
  v_mov_b32 v42, 0
  v_mov_b32 v43, 0
  v_mov_b32 v44, 0
  v_mov_b32 v45, 0
  v_mov_b32 v46, 0
  v_mov_b32 v47, 0
  v_mov_b32 v48, 0
  v_mov_b32 v49, 0
  v_mov_b32 v50, 0
  v_mov_b32 v51, 0
  v_mov_b32 v52, 0
  v_mov_b32 v53, 0
  v_mov_b32 v54, 0
  v_mov_b32 v55, 0
  v_mov_b32 v56, 0
  v_mov_b32 v57, 0
  v_mov_b32 v58, 0
  v_mov_b32 v59, 0
  v_mov_b32 v60, 0
  v_mov_b32 v61, 0
  v_mov_b32 v62, 0
  v_mov_b32 v63, 0
  v_mov_b32 v64, 0
  v_mov_b32 v65, 0
  v_mov_b32 v66, 0
  v_mov_b32 v67, 0
  v_mov_b32 v68, 0
  v_mov_b32 v69, 0
  v_mov_b32 v70, 0
  v_mov_b32 v71, 0
  v_mov_b32 v72, 0
  v_mov_b32 v73, 0
  v_mov_b32 v74, 0
  v_mov_b32 v75, 0
  v_mov_b32 v76, 0
  v_mov_b32 v77, 0
  v_mov_b32 v78, 0
  v_mov_b32 v79, 0
  v_mov_b32 v80, 0
  v_mov_b32 v81, 0
  v_mov_b32 v82, 0
  v_mov_b32 v83, 0
  v_mov_b32 v84, 0
  v_mov_b32 v85, 0
  v_mov_b32 v86, 0
  v_mov_b32 v87, 0
  v_mov_b32 v88, 0
  v_mov_b32 v89, 0
  v_mov_b32 v90, 0
  v_mov_b32 v91, 0
  v_mov_b32 v92, 0
  v_mov_b32 v93, 0
  v_mov_b32 v94, 0
  v_mov_b32 v95, 0
  v_mov_b32 v96, 0
  v_mov_b32 v97, 0
  v_mov_b32 v98, 0
  v_mov_b32 v99, 0
  v_mov_b32 v100, 0
  v_mov_b32 v101, 0
  v_mov_b32 v102, 0
  v_mov_b32 v103, 0
  v_mov_b32 v104, 0
  v_mov_b32 v105, 0
  v_mov_b32 v106, 0
  v_mov_b32 v107, 0
  v_mov_b32 v108, 0
  v_mov_b32 v109, 0
  v_mov_b32 v110, 0
  v_mov_b32 v111, 0
  s_mul_i32 s62, s48, 12288
  s_add_u32 s62, s62, 77824
  s_cmp_ge_u32 s50, 12
  s_cbranch_scc1 K1_HV
  s_cmp_ge_u32 s50, 8
  s_cselect_b32 s72, 48, 40
  s_movk_i32 s73, 2560
  s_cselect_b32 s73, 3072, s73
  s_mov_b32 s74, 2
  v_lshlrev_b32 v112, 2, v3
  v_mul_u32_u24 v113, s72, v2
  s_branch K1_HC
K1_HV:
  s_movk_i32 s73, 3072
  s_mov_b32 s74, 16
  v_mov_b32 v112, v2
  v_and_b32 v113, 1, v3
  v_mul_u32_u24 v113, 384, v113
  v_lshrrev_b32 v114, 1, v3
  v_lshl_add_u32 v113, v114, 3, v113
K1_HC:
  v_add_u32 v113, s62, v113
  v_add_u32 v114, 0, v112
  v_mul_u32_u24 v115, 0xccd, v114
  v_lshrrev_b32 v115, 16, v115
  v_mul_u32_u24 v116, 20, v115
  v_sub_u32 v116, v114, v116
  v_mul_u32_u24 v115, s73, v115
  v_mul_u32_u24 v116, s74, v116
  v_add_u32 v115, v115, v113
  v_add_u32 v17, v115, v116
  v_add_u32 v114, 16, v112
  v_mul_u32_u24 v115, 0xccd, v114
  v_lshrrev_b32 v115, 16, v115
  v_mul_u32_u24 v116, 20, v115
  v_sub_u32 v116, v114, v116
  v_mul_u32_u24 v115, s73, v115
  v_mul_u32_u24 v116, s74, v116
  v_add_u32 v115, v115, v113
  v_add_u32 v18, v115, v116
  v_add_u32 v114, 32, v112
  v_mul_u32_u24 v115, 0xccd, v114
  v_lshrrev_b32 v115, 16, v115
  v_mul_u32_u24 v116, 20, v115
  v_sub_u32 v116, v114, v116
  v_mul_u32_u24 v115, s73, v115
  v_mul_u32_u24 v116, s74, v116
  v_add_u32 v115, v115, v113
  v_add_u32 v19, v115, v116
  v_add_u32 v114, 48, v112
  v_mul_u32_u24 v115, 0xccd, v114
  v_lshrrev_b32 v115, 16, v115
  v_mul_u32_u24 v116, 20, v115
  v_sub_u32 v116, v114, v116
  v_mul_u32_u24 v115, s73, v115
  v_mul_u32_u24 v116, s74, v116
  v_add_u32 v115, v115, v113
  v_add_u32 v20, v115, v116
  v_add_u32 v114, 64, v112
  v_mul_u32_u24 v115, 0xccd, v114
  v_lshrrev_b32 v115, 16, v115
  v_mul_u32_u24 v116, 20, v115
  v_sub_u32 v116, v114, v116
  v_mul_u32_u24 v115, s73, v115
  v_mul_u32_u24 v116, s74, v116
  v_add_u32 v115, v115, v113
  v_add_u32 v21, v115, v116
  s_mov_b32 s64, 0xff00ff00
  s_mov_b32 s65, 0xff00ff00
  s_cmp_lt_u32 s50, 12
  s_cbranch_scc1 K1_ML_BQ
  s_branch K1_ML_BV
K1_ML_BV:
  s_mov_b32 s66, 0
  s_mov_b32 s67, 1
  s_barrier
  v_add_u32 v12, s66, v6
  v_add_u32 v13, s66, v7
  v_add_u32 v14, s66, v8
  v_add_u32 v15, s66, v9
  ds_read_b128 v[112:115], v12 offset:0
  ds_read_b128 v[116:119], v12 offset:2048
  ds_read_b128 v[120:123], v12 offset:4096
  ds_read_b128 v[124:127], v12 offset:6144
  ds_read_b64_tr_b16 v[128:129], v14 offset:0
  ds_read_b64_tr_b16 v[130:131], v14 offset:1280
  ds_read_b64_tr_b16 v[132:133], v15 offset:32
  ds_read_b64_tr_b16 v[134:135], v15 offset:1312
  ds_read_b64_tr_b16 v[136:137], v14 offset:64
  ds_read_b64_tr_b16 v[138:139], v14 offset:1344
  ds_read_b64_tr_b16 v[140:141], v15 offset:96
  ds_read_b64_tr_b16 v[142:143], v15 offset:1376
  ds_read_b64_tr_b16 v[144:145], v14 offset:128
  ds_read_b64_tr_b16 v[146:147], v14 offset:1408
  s_waitcnt lgkmcnt(0)
  v_mfma_f32_16x16x32_bf16 v[24:27], v[112:115], v[128:131], v[24:27]
  ds_read_b128 v[152:155], v13 offset:0
  v_mfma_f32_16x16x32_bf16 v[28:31], v[116:119], v[128:131], v[28:31]
  ds_read_b128 v[156:159], v13 offset:2048
  v_mfma_f32_16x16x32_bf16 v[32:35], v[120:123], v[128:131], v[32:35]
  ds_read_b128 v[160:163], v13 offset:4096
  v_mfma_f32_16x16x32_bf16 v[36:39], v[124:127], v[128:131], v[36:39]
  ds_read_b128 v[164:167], v13 offset:6144
  v_mfma_f32_16x16x32_bf16 v[40:43], v[112:115], v[132:135], v[40:43]
  ds_read_b64_tr_b16 v[168:169], v14 offset:10240
  v_mfma_f32_16x16x32_bf16 v[44:47], v[116:119], v[132:135], v[44:47]
  ds_read_b64_tr_b16 v[170:171], v14 offset:11520
  v_mfma_f32_16x16x32_bf16 v[48:51], v[120:123], v[132:135], v[48:51]
  ds_read_b64_tr_b16 v[172:173], v15 offset:10272
  v_mfma_f32_16x16x32_bf16 v[52:55], v[124:127], v[132:135], v[52:55]
  ds_read_b64_tr_b16 v[174:175], v15 offset:11552
  v_mfma_f32_16x16x32_bf16 v[56:59], v[112:115], v[136:139], v[56:59]
  ds_read_b64_tr_b16 v[176:177], v14 offset:10304
  v_mfma_f32_16x16x32_bf16 v[60:63], v[116:119], v[136:139], v[60:63]
  ds_read_b64_tr_b16 v[178:179], v14 offset:11584
  v_mfma_f32_16x16x32_bf16 v[64:67], v[120:123], v[136:139], v[64:67]
  ds_read_b64_tr_b16 v[180:181], v15 offset:10336
  v_mfma_f32_16x16x32_bf16 v[68:71], v[124:127], v[136:139], v[68:71]
  ds_read_b64_tr_b16 v[182:183], v15 offset:11616
  v_mfma_f32_16x16x32_bf16 v[72:75], v[112:115], v[140:143], v[72:75]
  ds_read_b64_tr_b16 v[184:185], v14 offset:10368
  v_mfma_f32_16x16x32_bf16 v[76:79], v[116:119], v[140:143], v[76:79]
  ds_read_b64_tr_b16 v[186:187], v14 offset:11648
  v_mfma_f32_16x16x32_bf16 v[80:83], v[120:123], v[140:143], v[80:83]
  v_mfma_f32_16x16x32_bf16 v[84:87], v[124:127], v[140:143], v[84:87]
  v_mfma_f32_16x16x32_bf16 v[88:91], v[112:115], v[144:147], v[88:91]
  v_mfma_f32_16x16x32_bf16 v[92:95], v[116:119], v[144:147], v[92:95]
  v_mfma_f32_16x16x32_bf16 v[96:99], v[120:123], v[144:147], v[96:99]
  v_mfma_f32_16x16x32_bf16 v[100:103], v[124:127], v[144:147], v[100:103]
  s_waitcnt lgkmcnt(0)
K1_LP_BV:
  s_add_u32 s66, s66, 38912
  s_cmp_eq_u32 s66, 155648
  s_cselect_b32 s66, 0, s66
  s_barrier
  v_add_u32 v12, s66, v6
  v_add_u32 v13, s66, v7
  v_add_u32 v14, s66, v8
  v_add_u32 v15, s66, v9
  v_mfma_f32_16x16x32_bf16 v[24:27], v[152:155], v[168:171], v[24:27]
  ds_read_b128 v[112:115], v12 offset:0
  v_mfma_f32_16x16x32_bf16 v[28:31], v[156:159], v[168:171], v[28:31]
  ds_read_b128 v[116:119], v12 offset:2048
  v_mfma_f32_16x16x32_bf16 v[32:35], v[160:163], v[168:171], v[32:35]
  ds_read_b128 v[120:123], v12 offset:4096
  v_mfma_f32_16x16x32_bf16 v[36:39], v[164:167], v[168:171], v[36:39]
  ds_read_b128 v[124:127], v12 offset:6144
  v_mfma_f32_16x16x32_bf16 v[40:43], v[152:155], v[172:175], v[40:43]
  ds_read_b64_tr_b16 v[128:129], v14 offset:0
  v_mfma_f32_16x16x32_bf16 v[44:47], v[156:159], v[172:175], v[44:47]
  ds_read_b64_tr_b16 v[130:131], v14 offset:1280
  v_mfma_f32_16x16x32_bf16 v[48:51], v[160:163], v[172:175], v[48:51]
  ds_read_b64_tr_b16 v[132:133], v15 offset:32
  v_mfma_f32_16x16x32_bf16 v[52:55], v[164:167], v[172:175], v[52:55]
  ds_read_b64_tr_b16 v[134:135], v15 offset:1312
  v_mfma_f32_16x16x32_bf16 v[56:59], v[152:155], v[176:179], v[56:59]
  ds_read_b64_tr_b16 v[136:137], v14 offset:64
  v_mfma_f32_16x16x32_bf16 v[60:63], v[156:159], v[176:179], v[60:63]
  ds_read_b64_tr_b16 v[138:139], v14 offset:1344
  v_mfma_f32_16x16x32_bf16 v[64:67], v[160:163], v[176:179], v[64:67]
  ds_read_b64_tr_b16 v[140:141], v15 offset:96
  v_mfma_f32_16x16x32_bf16 v[68:71], v[164:167], v[176:179], v[68:71]
  ds_read_b64_tr_b16 v[142:143], v15 offset:1376
  v_mfma_f32_16x16x32_bf16 v[72:75], v[152:155], v[180:183], v[72:75]
  ds_read_b64_tr_b16 v[144:145], v14 offset:128
  v_mfma_f32_16x16x32_bf16 v[76:79], v[156:159], v[180:183], v[76:79]
  ds_read_b64_tr_b16 v[146:147], v14 offset:1408
  v_mfma_f32_16x16x32_bf16 v[80:83], v[160:163], v[180:183], v[80:83]
  v_mfma_f32_16x16x32_bf16 v[84:87], v[164:167], v[180:183], v[84:87]
  v_mfma_f32_16x16x32_bf16 v[88:91], v[152:155], v[184:187], v[88:91]
  v_mfma_f32_16x16x32_bf16 v[92:95], v[156:159], v[184:187], v[92:95]
  v_mfma_f32_16x16x32_bf16 v[96:99], v[160:163], v[184:187], v[96:99]
  v_mfma_f32_16x16x32_bf16 v[100:103], v[164:167], v[184:187], v[100:103]
  s_waitcnt lgkmcnt(0)
  v_mfma_f32_16x16x32_bf16 v[24:27], v[112:115], v[128:131], v[24:27]
  ds_read_b128 v[152:155], v13 offset:0
  v_mfma_f32_16x16x32_bf16 v[28:31], v[116:119], v[128:131], v[28:31]
  ds_read_b128 v[156:159], v13 offset:2048
  v_mfma_f32_16x16x32_bf16 v[32:35], v[120:123], v[128:131], v[32:35]
  ds_read_b128 v[160:163], v13 offset:4096
  v_mfma_f32_16x16x32_bf16 v[36:39], v[124:127], v[128:131], v[36:39]
  ds_read_b128 v[164:167], v13 offset:6144
  v_mfma_f32_16x16x32_bf16 v[40:43], v[112:115], v[132:135], v[40:43]
  ds_read_b64_tr_b16 v[168:169], v14 offset:10240
  v_mfma_f32_16x16x32_bf16 v[44:47], v[116:119], v[132:135], v[44:47]
  ds_read_b64_tr_b16 v[170:171], v14 offset:11520
  v_mfma_f32_16x16x32_bf16 v[48:51], v[120:123], v[132:135], v[48:51]
  ds_read_b64_tr_b16 v[172:173], v15 offset:10272
  v_mfma_f32_16x16x32_bf16 v[52:55], v[124:127], v[132:135], v[52:55]
  ds_read_b64_tr_b16 v[174:175], v15 offset:11552
  v_mfma_f32_16x16x32_bf16 v[56:59], v[112:115], v[136:139], v[56:59]
  ds_read_b64_tr_b16 v[176:177], v14 offset:10304
  v_mfma_f32_16x16x32_bf16 v[60:63], v[116:119], v[136:139], v[60:63]
  ds_read_b64_tr_b16 v[178:179], v14 offset:11584
  v_mfma_f32_16x16x32_bf16 v[64:67], v[120:123], v[136:139], v[64:67]
  ds_read_b64_tr_b16 v[180:181], v15 offset:10336
  v_mfma_f32_16x16x32_bf16 v[68:71], v[124:127], v[136:139], v[68:71]
  ds_read_b64_tr_b16 v[182:183], v15 offset:11616
  v_mfma_f32_16x16x32_bf16 v[72:75], v[112:115], v[140:143], v[72:75]
  ds_read_b64_tr_b16 v[184:185], v14 offset:10368
  v_mfma_f32_16x16x32_bf16 v[76:79], v[116:119], v[140:143], v[76:79]
  ds_read_b64_tr_b16 v[186:187], v14 offset:11648
  v_mfma_f32_16x16x32_bf16 v[80:83], v[120:123], v[140:143], v[80:83]
  v_mfma_f32_16x16x32_bf16 v[84:87], v[124:127], v[140:143], v[84:87]
  v_mfma_f32_16x16x32_bf16 v[88:91], v[112:115], v[144:147], v[88:91]
  v_mfma_f32_16x16x32_bf16 v[92:95], v[116:119], v[144:147], v[92:95]
  v_mfma_f32_16x16x32_bf16 v[96:99], v[120:123], v[144:147], v[96:99]
  v_mfma_f32_16x16x32_bf16 v[100:103], v[124:127], v[144:147], v[100:103]
  s_waitcnt lgkmcnt(0)
  s_add_u32 s67, s67, 1
  s_cmp_lt_u32 s67, 10
  s_cbranch_scc1 K1_LP_BV
  v_mfma_f32_16x16x32_bf16 v[24:27], v[152:155], v[168:171], v[24:27]
  v_mfma_f32_16x16x32_bf16 v[28:31], v[156:159], v[168:171], v[28:31]
  v_mfma_f32_16x16x32_bf16 v[32:35], v[160:163], v[168:171], v[32:35]
  v_mfma_f32_16x16x32_bf16 v[36:39], v[164:167], v[168:171], v[36:39]
  v_mfma_f32_16x16x32_bf16 v[40:43], v[152:155], v[172:175], v[40:43]
  v_mfma_f32_16x16x32_bf16 v[44:47], v[156:159], v[172:175], v[44:47]
  v_mfma_f32_16x16x32_bf16 v[48:51], v[160:163], v[172:175], v[48:51]
  v_mfma_f32_16x16x32_bf16 v[52:55], v[164:167], v[172:175], v[52:55]
  v_mfma_f32_16x16x32_bf16 v[56:59], v[152:155], v[176:179], v[56:59]
  v_mfma_f32_16x16x32_bf16 v[60:63], v[156:159], v[176:179], v[60:63]
  v_mfma_f32_16x16x32_bf16 v[64:67], v[160:163], v[176:179], v[64:67]
  v_mfma_f32_16x16x32_bf16 v[68:71], v[164:167], v[176:179], v[68:71]
  v_mfma_f32_16x16x32_bf16 v[72:75], v[152:155], v[180:183], v[72:75]
  v_mfma_f32_16x16x32_bf16 v[76:79], v[156:159], v[180:183], v[76:79]
  v_mfma_f32_16x16x32_bf16 v[80:83], v[160:163], v[180:183], v[80:83]
  v_mfma_f32_16x16x32_bf16 v[84:87], v[164:167], v[180:183], v[84:87]
  v_mfma_f32_16x16x32_bf16 v[88:91], v[152:155], v[184:187], v[88:91]
  v_mfma_f32_16x16x32_bf16 v[92:95], v[156:159], v[184:187], v[92:95]
  v_mfma_f32_16x16x32_bf16 v[96:99], v[160:163], v[184:187], v[96:99]
  v_mfma_f32_16x16x32_bf16 v[100:103], v[164:167], v[184:187], v[100:103]
  s_nop 7
  s_nop 1
  s_lshl_b32 s62, s49, 7
  s_lshl_b32 s63, s60, 6
  s_add_u32 s62, s62, s63
  s_and_b32 s63, s50, 3
  s_lshl_b32 s63, s63, 3
  s_lshl_b32 s68, s61, 2
  s_add_u32 s63, s63, s68
  s_mul_i32 s69, s48, 12288
  s_add_u32 s69, s69, 77824
  v_lshlrev_b32 v113, 4, v1
  v_add_u32 v112, s69, v113
  v_lshrrev_b32 v114, 5, v1
  s_mul_i32 s68, s63, 196608
  s_lshr_b32 s69, s62, 5
  s_mul_i32 s69, s69, 3072
  s_add_u32 s68, s68, s69
  s_add_u32 s68, s68, 5506560
  s_mul_i32 s69, s48, 12288
  s_add_u32 s69, s69, 77824
  v_lshrrev_b32 v115, 2, v1
  v_mul_u32_u24 v115, 384, v115
  v_and_b32 v116, 3, v1
  v_lshl_add_u32 v115, v116, 4, v115
  v_add_u32 v115, 320, v115
  v_add_u32 v115, s69, v115
  v_cmp_eq_u32 vcc, 0, v116
  v_mov_b32 v117, 0x3f803f80
  s_nop 0
  v_cndmask_b32 v140, 0, v117, vcc
  v_mov_b32 v141, v140
  v_mov_b32 v142, v140
  v_mov_b32 v143, v140
  ds_write_b128 v115, v[140:143] offset:0
  ds_write_b128 v115, v[140:143] offset:6144
  v_mul_u32_u24 v114, 1536, v114
  v_add_u32 v114, v114, v113
  v_cvt_pk_bf16_f32 v120, v24, v25
  v_cvt_pk_bf16_f32 v121, v26, v27
  ds_write_b64 v17, v[120:121] offset:0
  v_cvt_pk_bf16_f32 v122, v28, v29
  v_cvt_pk_bf16_f32 v123, v30, v31
  ds_write_b64 v17, v[122:123] offset:768
  v_cvt_pk_bf16_f32 v124, v32, v33
  v_cvt_pk_bf16_f32 v125, v34, v35
  ds_write_b64 v17, v[124:125] offset:1536
  v_cvt_pk_bf16_f32 v126, v36, v37
  v_cvt_pk_bf16_f32 v127, v38, v39
  ds_write_b64 v17, v[126:127] offset:2304
  v_cvt_pk_bf16_f32 v128, v40, v41
  v_cvt_pk_bf16_f32 v129, v42, v43
  ds_write_b64 v18, v[128:129] offset:0
  v_cvt_pk_bf16_f32 v130, v44, v45
  v_cvt_pk_bf16_f32 v131, v46, v47
  ds_write_b64 v18, v[130:131] offset:768
  v_cvt_pk_bf16_f32 v132, v48, v49
  v_cvt_pk_bf16_f32 v133, v50, v51
  ds_write_b64 v18, v[132:133] offset:1536
  v_cvt_pk_bf16_f32 v134, v52, v53
  v_cvt_pk_bf16_f32 v135, v54, v55
  ds_write_b64 v18, v[134:135] offset:2304
  v_cvt_pk_bf16_f32 v120, v56, v57
  v_cvt_pk_bf16_f32 v121, v58, v59
  ds_write_b64 v19, v[120:121] offset:0
  v_cvt_pk_bf16_f32 v122, v60, v61
  v_cvt_pk_bf16_f32 v123, v62, v63
  ds_write_b64 v19, v[122:123] offset:768
  v_cvt_pk_bf16_f32 v124, v64, v65
  v_cvt_pk_bf16_f32 v125, v66, v67
  ds_write_b64 v19, v[124:125] offset:1536
  v_cvt_pk_bf16_f32 v126, v68, v69
  v_cvt_pk_bf16_f32 v127, v70, v71
  ds_write_b64 v19, v[126:127] offset:2304
  v_cvt_pk_bf16_f32 v128, v72, v73
  v_cvt_pk_bf16_f32 v129, v74, v75
  ds_write_b64 v20, v[128:129] offset:0
  v_cvt_pk_bf16_f32 v130, v76, v77
  v_cvt_pk_bf16_f32 v131, v78, v79
  ds_write_b64 v20, v[130:131] offset:768
  v_cvt_pk_bf16_f32 v132, v80, v81
  v_cvt_pk_bf16_f32 v133, v82, v83
  ds_write_b64 v20, v[132:133] offset:1536
  v_cvt_pk_bf16_f32 v134, v84, v85
  v_cvt_pk_bf16_f32 v135, v86, v87
  ds_write_b64 v20, v[134:135] offset:2304
  v_cvt_pk_bf16_f32 v120, v88, v89
  v_cvt_pk_bf16_f32 v121, v90, v91
  ds_write_b64 v21, v[120:121] offset:0
  v_cvt_pk_bf16_f32 v122, v92, v93
  v_cvt_pk_bf16_f32 v123, v94, v95
  ds_write_b64 v21, v[122:123] offset:768
  v_cvt_pk_bf16_f32 v124, v96, v97
  v_cvt_pk_bf16_f32 v125, v98, v99
  ds_write_b64 v21, v[124:125] offset:1536
  v_cvt_pk_bf16_f32 v126, v100, v101
  v_cvt_pk_bf16_f32 v127, v102, v103
  ds_write_b64 v21, v[126:127] offset:2304
  s_waitcnt lgkmcnt(0)
  ds_read_b128 v[24:27], v112 offset:0
  ds_read_b128 v[28:31], v112 offset:1024
  ds_read_b128 v[32:35], v112 offset:2048
  ds_read_b128 v[36:39], v112 offset:3072
  ds_read_b128 v[40:43], v112 offset:4096
  ds_read_b128 v[44:47], v112 offset:5120
  ds_read_b128 v[48:51], v112 offset:6144
  ds_read_b128 v[52:55], v112 offset:7168
  ds_read_b128 v[56:59], v112 offset:8192
  ds_read_b128 v[60:63], v112 offset:9216
  ds_read_b128 v[64:67], v112 offset:10240
  ds_read_b128 v[68:71], v112 offset:11264
  s_waitcnt lgkmcnt(11)
  buffer_store_dwordx4 v[24:27], v113, s[40:43], s68 offen offset:0 sc1
  s_waitcnt lgkmcnt(10)
  buffer_store_dwordx4 v[28:31], v114, s[40:43], s68 offen offset:1024 sc1
  s_waitcnt lgkmcnt(9)
  buffer_store_dwordx4 v[32:35], v113, s[40:43], s68 offen offset:3584 sc1
  s_add_u32 s68, s68, 196608
  s_waitcnt lgkmcnt(8)
  buffer_store_dwordx4 v[36:39], v113, s[40:43], s68 offen offset:0 sc1
  s_waitcnt lgkmcnt(7)
  buffer_store_dwordx4 v[40:43], v114, s[40:43], s68 offen offset:1024 sc1
  s_waitcnt lgkmcnt(6)
  buffer_store_dwordx4 v[44:47], v113, s[40:43], s68 offen offset:3584 sc1
  s_add_u32 s68, s68, 196608
  s_waitcnt lgkmcnt(5)
  buffer_store_dwordx4 v[48:51], v113, s[40:43], s68 offen offset:0 sc1
  s_waitcnt lgkmcnt(4)
  buffer_store_dwordx4 v[52:55], v114, s[40:43], s68 offen offset:1024
  s_waitcnt lgkmcnt(3)
  buffer_store_dwordx4 v[56:59], v113, s[40:43], s68 offen offset:3584
  s_add_u32 s68, s68, 196608
  s_waitcnt lgkmcnt(2)
  buffer_store_dwordx4 v[60:63], v113, s[40:43], s68 offen offset:0
  s_waitcnt lgkmcnt(1)
  buffer_store_dwordx4 v[64:67], v114, s[40:43], s68 offen offset:1024
  s_waitcnt lgkmcnt(0)
  buffer_store_dwordx4 v[68:71], v113, s[40:43], s68 offen offset:3584
  s_endpgm
K1_ML_BQ:
  s_mov_b32 s66, 0
  s_mov_b32 s67, 1
  s_barrier
  v_add_u32 v12, s66, v6
  v_add_u32 v13, s66, v7
  v_add_u32 v14, s66, v8
  v_add_u32 v15, s66, v9
  ds_read_b128 v[112:115], v12 offset:0
  ds_read_b128 v[116:119], v12 offset:2048
  ds_read_b128 v[120:123], v12 offset:4096
  ds_read_b128 v[124:127], v12 offset:6144
  ds_read_b64_tr_b16 v[128:129], v14 offset:0
  ds_read_b64_tr_b16 v[130:131], v14 offset:1280
  ds_read_b64_tr_b16 v[132:133], v15 offset:32
  ds_read_b64_tr_b16 v[134:135], v15 offset:1312
  ds_read_b64_tr_b16 v[136:137], v14 offset:64
  ds_read_b64_tr_b16 v[138:139], v14 offset:1344
  ds_read_b64_tr_b16 v[140:141], v15 offset:96
  ds_read_b64_tr_b16 v[142:143], v15 offset:1376
  ds_read_b64_tr_b16 v[144:145], v14 offset:128
  ds_read_b64_tr_b16 v[146:147], v14 offset:1408
  s_waitcnt lgkmcnt(0)
  v_mfma_f32_16x16x32_bf16 v[24:27], v[128:131], v[112:115], v[24:27]
  ds_read_b128 v[152:155], v13 offset:0
  v_mfma_f32_16x16x32_bf16 v[28:31], v[128:131], v[116:119], v[28:31]
  ds_read_b128 v[156:159], v13 offset:2048
  v_mfma_f32_16x16x32_bf16 v[32:35], v[128:131], v[120:123], v[32:35]
  ds_read_b128 v[160:163], v13 offset:4096
  v_mfma_f32_16x16x32_bf16 v[36:39], v[128:131], v[124:127], v[36:39]
  ds_read_b128 v[164:167], v13 offset:6144
  v_mfma_f32_16x16x32_bf16 v[40:43], v[132:135], v[112:115], v[40:43]
  ds_read_b64_tr_b16 v[168:169], v14 offset:10240
  v_mfma_f32_16x16x32_bf16 v[44:47], v[132:135], v[116:119], v[44:47]
  ds_read_b64_tr_b16 v[170:171], v14 offset:11520
  v_mfma_f32_16x16x32_bf16 v[48:51], v[132:135], v[120:123], v[48:51]
  ds_read_b64_tr_b16 v[172:173], v15 offset:10272
  v_mfma_f32_16x16x32_bf16 v[52:55], v[132:135], v[124:127], v[52:55]
  ds_read_b64_tr_b16 v[174:175], v15 offset:11552
  v_mfma_f32_16x16x32_bf16 v[56:59], v[136:139], v[112:115], v[56:59]
  ds_read_b64_tr_b16 v[176:177], v14 offset:10304
  v_mfma_f32_16x16x32_bf16 v[60:63], v[136:139], v[116:119], v[60:63]
  ds_read_b64_tr_b16 v[178:179], v14 offset:11584
  v_mfma_f32_16x16x32_bf16 v[64:67], v[136:139], v[120:123], v[64:67]
  ds_read_b64_tr_b16 v[180:181], v15 offset:10336
  v_mfma_f32_16x16x32_bf16 v[68:71], v[136:139], v[124:127], v[68:71]
  ds_read_b64_tr_b16 v[182:183], v15 offset:11616
  v_mfma_f32_16x16x32_bf16 v[72:75], v[140:143], v[112:115], v[72:75]
  ds_read_b64_tr_b16 v[184:185], v14 offset:10368
  v_mfma_f32_16x16x32_bf16 v[76:79], v[140:143], v[116:119], v[76:79]
  ds_read_b64_tr_b16 v[186:187], v14 offset:11648
  v_mfma_f32_16x16x32_bf16 v[80:83], v[140:143], v[120:123], v[80:83]
  v_mfma_f32_16x16x32_bf16 v[84:87], v[140:143], v[124:127], v[84:87]
  v_mfma_f32_16x16x32_bf16 v[88:91], v[144:147], v[112:115], v[88:91]
  v_mfma_f32_16x16x32_bf16 v[92:95], v[144:147], v[116:119], v[92:95]
  v_mfma_f32_16x16x32_bf16 v[96:99], v[144:147], v[120:123], v[96:99]
  v_mfma_f32_16x16x32_bf16 v[100:103], v[144:147], v[124:127], v[100:103]
  s_waitcnt lgkmcnt(0)
K1_LP_BQ:
  s_add_u32 s66, s66, 38912
  s_cmp_eq_u32 s66, 155648
  s_cselect_b32 s66, 0, s66
  s_barrier
  v_add_u32 v12, s66, v6
  v_add_u32 v13, s66, v7
  v_add_u32 v14, s66, v8
  v_add_u32 v15, s66, v9
  v_mfma_f32_16x16x32_bf16 v[24:27], v[168:171], v[152:155], v[24:27]
  ds_read_b128 v[112:115], v12 offset:0
  v_mfma_f32_16x16x32_bf16 v[28:31], v[168:171], v[156:159], v[28:31]
  ds_read_b128 v[116:119], v12 offset:2048
  v_mfma_f32_16x16x32_bf16 v[32:35], v[168:171], v[160:163], v[32:35]
  ds_read_b128 v[120:123], v12 offset:4096
  v_mfma_f32_16x16x32_bf16 v[36:39], v[168:171], v[164:167], v[36:39]
  ds_read_b128 v[124:127], v12 offset:6144
  v_mfma_f32_16x16x32_bf16 v[40:43], v[172:175], v[152:155], v[40:43]
  ds_read_b64_tr_b16 v[128:129], v14 offset:0
  v_mfma_f32_16x16x32_bf16 v[44:47], v[172:175], v[156:159], v[44:47]
  ds_read_b64_tr_b16 v[130:131], v14 offset:1280
  v_mfma_f32_16x16x32_bf16 v[48:51], v[172:175], v[160:163], v[48:51]
  ds_read_b64_tr_b16 v[132:133], v15 offset:32
  v_mfma_f32_16x16x32_bf16 v[52:55], v[172:175], v[164:167], v[52:55]
  ds_read_b64_tr_b16 v[134:135], v15 offset:1312
  v_mfma_f32_16x16x32_bf16 v[56:59], v[176:179], v[152:155], v[56:59]
  ds_read_b64_tr_b16 v[136:137], v14 offset:64
  v_mfma_f32_16x16x32_bf16 v[60:63], v[176:179], v[156:159], v[60:63]
  ds_read_b64_tr_b16 v[138:139], v14 offset:1344
  v_mfma_f32_16x16x32_bf16 v[64:67], v[176:179], v[160:163], v[64:67]
  ds_read_b64_tr_b16 v[140:141], v15 offset:96
  v_mfma_f32_16x16x32_bf16 v[68:71], v[176:179], v[164:167], v[68:71]
  ds_read_b64_tr_b16 v[142:143], v15 offset:1376
  v_mfma_f32_16x16x32_bf16 v[72:75], v[180:183], v[152:155], v[72:75]
  ds_read_b64_tr_b16 v[144:145], v14 offset:128
  v_mfma_f32_16x16x32_bf16 v[76:79], v[180:183], v[156:159], v[76:79]
  ds_read_b64_tr_b16 v[146:147], v14 offset:1408
  v_mfma_f32_16x16x32_bf16 v[80:83], v[180:183], v[160:163], v[80:83]
  v_mfma_f32_16x16x32_bf16 v[84:87], v[180:183], v[164:167], v[84:87]
  v_mfma_f32_16x16x32_bf16 v[88:91], v[184:187], v[152:155], v[88:91]
  v_mfma_f32_16x16x32_bf16 v[92:95], v[184:187], v[156:159], v[92:95]
  v_mfma_f32_16x16x32_bf16 v[96:99], v[184:187], v[160:163], v[96:99]
  v_mfma_f32_16x16x32_bf16 v[100:103], v[184:187], v[164:167], v[100:103]
  s_waitcnt lgkmcnt(0)
  v_mfma_f32_16x16x32_bf16 v[24:27], v[128:131], v[112:115], v[24:27]
  ds_read_b128 v[152:155], v13 offset:0
  v_mfma_f32_16x16x32_bf16 v[28:31], v[128:131], v[116:119], v[28:31]
  ds_read_b128 v[156:159], v13 offset:2048
  v_mfma_f32_16x16x32_bf16 v[32:35], v[128:131], v[120:123], v[32:35]
  ds_read_b128 v[160:163], v13 offset:4096
  v_mfma_f32_16x16x32_bf16 v[36:39], v[128:131], v[124:127], v[36:39]
  ds_read_b128 v[164:167], v13 offset:6144
  v_mfma_f32_16x16x32_bf16 v[40:43], v[132:135], v[112:115], v[40:43]
  ds_read_b64_tr_b16 v[168:169], v14 offset:10240
  v_mfma_f32_16x16x32_bf16 v[44:47], v[132:135], v[116:119], v[44:47]
  ds_read_b64_tr_b16 v[170:171], v14 offset:11520
  v_mfma_f32_16x16x32_bf16 v[48:51], v[132:135], v[120:123], v[48:51]
  ds_read_b64_tr_b16 v[172:173], v15 offset:10272
  v_mfma_f32_16x16x32_bf16 v[52:55], v[132:135], v[124:127], v[52:55]
  ds_read_b64_tr_b16 v[174:175], v15 offset:11552
  v_mfma_f32_16x16x32_bf16 v[56:59], v[136:139], v[112:115], v[56:59]
  ds_read_b64_tr_b16 v[176:177], v14 offset:10304
  v_mfma_f32_16x16x32_bf16 v[60:63], v[136:139], v[116:119], v[60:63]
  ds_read_b64_tr_b16 v[178:179], v14 offset:11584
  v_mfma_f32_16x16x32_bf16 v[64:67], v[136:139], v[120:123], v[64:67]
  ds_read_b64_tr_b16 v[180:181], v15 offset:10336
  v_mfma_f32_16x16x32_bf16 v[68:71], v[136:139], v[124:127], v[68:71]
  ds_read_b64_tr_b16 v[182:183], v15 offset:11616
  v_mfma_f32_16x16x32_bf16 v[72:75], v[140:143], v[112:115], v[72:75]
  ds_read_b64_tr_b16 v[184:185], v14 offset:10368
  v_mfma_f32_16x16x32_bf16 v[76:79], v[140:143], v[116:119], v[76:79]
  ds_read_b64_tr_b16 v[186:187], v14 offset:11648
  v_mfma_f32_16x16x32_bf16 v[80:83], v[140:143], v[120:123], v[80:83]
  v_mfma_f32_16x16x32_bf16 v[84:87], v[140:143], v[124:127], v[84:87]
  v_mfma_f32_16x16x32_bf16 v[88:91], v[144:147], v[112:115], v[88:91]
  v_mfma_f32_16x16x32_bf16 v[92:95], v[144:147], v[116:119], v[92:95]
  v_mfma_f32_16x16x32_bf16 v[96:99], v[144:147], v[120:123], v[96:99]
  v_mfma_f32_16x16x32_bf16 v[100:103], v[144:147], v[124:127], v[100:103]
  s_waitcnt lgkmcnt(0)
  s_add_u32 s67, s67, 1
  s_cmp_lt_u32 s67, 10
  s_cbranch_scc1 K1_LP_BQ
  v_mfma_f32_16x16x32_bf16 v[24:27], v[168:171], v[152:155], v[24:27]
  v_mfma_f32_16x16x32_bf16 v[28:31], v[168:171], v[156:159], v[28:31]
  v_mfma_f32_16x16x32_bf16 v[32:35], v[168:171], v[160:163], v[32:35]
  v_mfma_f32_16x16x32_bf16 v[36:39], v[168:171], v[164:167], v[36:39]
  v_mfma_f32_16x16x32_bf16 v[40:43], v[172:175], v[152:155], v[40:43]
  v_mfma_f32_16x16x32_bf16 v[44:47], v[172:175], v[156:159], v[44:47]
  v_mfma_f32_16x16x32_bf16 v[48:51], v[172:175], v[160:163], v[48:51]
  v_mfma_f32_16x16x32_bf16 v[52:55], v[172:175], v[164:167], v[52:55]
  v_mfma_f32_16x16x32_bf16 v[56:59], v[176:179], v[152:155], v[56:59]
  v_mfma_f32_16x16x32_bf16 v[60:63], v[176:179], v[156:159], v[60:63]
  v_mfma_f32_16x16x32_bf16 v[64:67], v[176:179], v[160:163], v[64:67]
  v_mfma_f32_16x16x32_bf16 v[68:71], v[176:179], v[164:167], v[68:71]
  v_mfma_f32_16x16x32_bf16 v[72:75], v[180:183], v[152:155], v[72:75]
  v_mfma_f32_16x16x32_bf16 v[76:79], v[180:183], v[156:159], v[76:79]
  v_mfma_f32_16x16x32_bf16 v[80:83], v[180:183], v[160:163], v[80:83]
  v_mfma_f32_16x16x32_bf16 v[84:87], v[180:183], v[164:167], v[84:87]
  v_mfma_f32_16x16x32_bf16 v[88:91], v[184:187], v[152:155], v[88:91]
  v_mfma_f32_16x16x32_bf16 v[92:95], v[184:187], v[156:159], v[92:95]
  v_mfma_f32_16x16x32_bf16 v[96:99], v[184:187], v[160:163], v[96:99]
  v_mfma_f32_16x16x32_bf16 v[100:103], v[184:187], v[164:167], v[100:103]
  s_nop 7
  s_nop 1
  s_cmp_ge_u32 s50, 8
  s_cbranch_scc1 K1_EPIK
  s_cmp_lt_u32 s50, 4
  s_cselect_b32 s77, 0, 2621440
  s_lshl_b32 s62, s49, 7
  s_lshl_b32 s63, s60, 6
  s_add_u32 s62, s62, s63
  s_and_b32 s63, s50, 3
  s_lshl_b32 s63, s63, 3
  s_lshl_b32 s68, s61, 2
  s_add_u32 s63, s63, s68
  s_mul_i32 s69, s48, 12288
  s_add_u32 s69, s69, 77824
  v_lshlrev_b32 v113, 4, v1
  v_add_u32 v112, s69, v113
  v_lshrrev_b32 v114, 5, v1
  s_mul_i32 s68, s63, 81920
  s_mul_i32 s69, s62, 40
  s_add_u32 s68, s68, s69
  s_add_u32 s68, s68, s77
  v_mul_u32_u24 v114, 79360, v114
  v_add_u32 v114, v114, v113
  s_mov_b32 s70, 1051011932
  s_mov_b32 s71, 1051011932
  v_pk_mul_f32 v[24:25], v[24:25], s[70:71]
  v_pk_mul_f32 v[26:27], v[26:27], s[70:71]
  v_cvt_pk_bf16_f32 v120, v24, v25
  v_cvt_pk_bf16_f32 v121, v26, v27
  ds_write_b64 v17, v[120:121] offset:0
  v_pk_mul_f32 v[28:29], v[28:29], s[70:71]
  v_pk_mul_f32 v[30:31], v[30:31], s[70:71]
  v_cvt_pk_bf16_f32 v122, v28, v29
  v_cvt_pk_bf16_f32 v123, v30, v31
  ds_write_b64 v17, v[122:123] offset:640
  v_pk_mul_f32 v[32:33], v[32:33], s[70:71]
  v_pk_mul_f32 v[34:35], v[34:35], s[70:71]
  v_cvt_pk_bf16_f32 v124, v32, v33
  v_cvt_pk_bf16_f32 v125, v34, v35
  ds_write_b64 v17, v[124:125] offset:1280
  v_pk_mul_f32 v[36:37], v[36:37], s[70:71]
  v_pk_mul_f32 v[38:39], v[38:39], s[70:71]
  v_cvt_pk_bf16_f32 v126, v36, v37
  v_cvt_pk_bf16_f32 v127, v38, v39
  ds_write_b64 v17, v[126:127] offset:1920
  v_pk_mul_f32 v[40:41], v[40:41], s[70:71]
  v_pk_mul_f32 v[42:43], v[42:43], s[70:71]
  v_cvt_pk_bf16_f32 v128, v40, v41
  v_cvt_pk_bf16_f32 v129, v42, v43
  ds_write_b64 v18, v[128:129] offset:0
  v_pk_mul_f32 v[44:45], v[44:45], s[70:71]
  v_pk_mul_f32 v[46:47], v[46:47], s[70:71]
  v_cvt_pk_bf16_f32 v130, v44, v45
  v_cvt_pk_bf16_f32 v131, v46, v47
  ds_write_b64 v18, v[130:131] offset:640
  v_pk_mul_f32 v[48:49], v[48:49], s[70:71]
  v_pk_mul_f32 v[50:51], v[50:51], s[70:71]
  v_cvt_pk_bf16_f32 v132, v48, v49
  v_cvt_pk_bf16_f32 v133, v50, v51
  ds_write_b64 v18, v[132:133] offset:1280
  v_pk_mul_f32 v[52:53], v[52:53], s[70:71]
  v_pk_mul_f32 v[54:55], v[54:55], s[70:71]
  v_cvt_pk_bf16_f32 v134, v52, v53
  v_cvt_pk_bf16_f32 v135, v54, v55
  ds_write_b64 v18, v[134:135] offset:1920
  v_pk_mul_f32 v[56:57], v[56:57], s[70:71]
  v_pk_mul_f32 v[58:59], v[58:59], s[70:71]
  v_cvt_pk_bf16_f32 v120, v56, v57
  v_cvt_pk_bf16_f32 v121, v58, v59
  ds_write_b64 v19, v[120:121] offset:0
  v_pk_mul_f32 v[60:61], v[60:61], s[70:71]
  v_pk_mul_f32 v[62:63], v[62:63], s[70:71]
  v_cvt_pk_bf16_f32 v122, v60, v61
  v_cvt_pk_bf16_f32 v123, v62, v63
  ds_write_b64 v19, v[122:123] offset:640
  v_pk_mul_f32 v[64:65], v[64:65], s[70:71]
  v_pk_mul_f32 v[66:67], v[66:67], s[70:71]
  v_cvt_pk_bf16_f32 v124, v64, v65
  v_cvt_pk_bf16_f32 v125, v66, v67
  ds_write_b64 v19, v[124:125] offset:1280
  v_pk_mul_f32 v[68:69], v[68:69], s[70:71]
  v_pk_mul_f32 v[70:71], v[70:71], s[70:71]
  v_cvt_pk_bf16_f32 v126, v68, v69
  v_cvt_pk_bf16_f32 v127, v70, v71
  ds_write_b64 v19, v[126:127] offset:1920
  v_pk_mul_f32 v[72:73], v[72:73], s[70:71]
  v_pk_mul_f32 v[74:75], v[74:75], s[70:71]
  v_cvt_pk_bf16_f32 v128, v72, v73
  v_cvt_pk_bf16_f32 v129, v74, v75
  ds_write_b64 v20, v[128:129] offset:0
  v_pk_mul_f32 v[76:77], v[76:77], s[70:71]
  v_pk_mul_f32 v[78:79], v[78:79], s[70:71]
  v_cvt_pk_bf16_f32 v130, v76, v77
  v_cvt_pk_bf16_f32 v131, v78, v79
  ds_write_b64 v20, v[130:131] offset:640
  v_pk_mul_f32 v[80:81], v[80:81], s[70:71]
  v_pk_mul_f32 v[82:83], v[82:83], s[70:71]
  v_cvt_pk_bf16_f32 v132, v80, v81
  v_cvt_pk_bf16_f32 v133, v82, v83
  ds_write_b64 v20, v[132:133] offset:1280
  v_pk_mul_f32 v[84:85], v[84:85], s[70:71]
  v_pk_mul_f32 v[86:87], v[86:87], s[70:71]
  v_cvt_pk_bf16_f32 v134, v84, v85
  v_cvt_pk_bf16_f32 v135, v86, v87
  ds_write_b64 v20, v[134:135] offset:1920
  v_pk_mul_f32 v[88:89], v[88:89], s[70:71]
  v_pk_mul_f32 v[90:91], v[90:91], s[70:71]
  v_cvt_pk_bf16_f32 v120, v88, v89
  v_cvt_pk_bf16_f32 v121, v90, v91
  ds_write_b64 v21, v[120:121] offset:0
  v_pk_mul_f32 v[92:93], v[92:93], s[70:71]
  v_pk_mul_f32 v[94:95], v[94:95], s[70:71]
  v_cvt_pk_bf16_f32 v122, v92, v93
  v_cvt_pk_bf16_f32 v123, v94, v95
  ds_write_b64 v21, v[122:123] offset:640
  v_pk_mul_f32 v[96:97], v[96:97], s[70:71]
  v_pk_mul_f32 v[98:99], v[98:99], s[70:71]
  v_cvt_pk_bf16_f32 v124, v96, v97
  v_cvt_pk_bf16_f32 v125, v98, v99
  ds_write_b64 v21, v[124:125] offset:1280
  v_pk_mul_f32 v[100:101], v[100:101], s[70:71]
  v_pk_mul_f32 v[102:103], v[102:103], s[70:71]
  v_cvt_pk_bf16_f32 v126, v100, v101
  v_cvt_pk_bf16_f32 v127, v102, v103
  ds_write_b64 v21, v[126:127] offset:1920
  s_waitcnt lgkmcnt(0)
  ds_read_b128 v[24:27], v112 offset:0
  ds_read_b128 v[28:31], v112 offset:1024
  ds_read_b128 v[32:35], v112 offset:2048
  ds_read_b128 v[36:39], v112 offset:3072
  ds_read_b128 v[40:43], v112 offset:4096
  ds_read_b128 v[44:47], v112 offset:5120
  ds_read_b128 v[48:51], v112 offset:6144
  ds_read_b128 v[52:55], v112 offset:7168
  ds_read_b128 v[56:59], v112 offset:8192
  ds_read_b128 v[60:63], v112 offset:9216
  s_add_u32 s69, s68, 0
  s_waitcnt lgkmcnt(9)
  buffer_store_dwordx4 v[24:27], v113, s[40:43], s69 offen sc1
  s_add_u32 s69, s68, 1024
  s_waitcnt lgkmcnt(8)
  buffer_store_dwordx4 v[28:31], v113, s[40:43], s69 offen sc1
  s_add_u32 s69, s68, 2048
  s_waitcnt lgkmcnt(7)
  buffer_store_dwordx4 v[32:35], v114, s[40:43], s69 offen sc1
  s_add_u32 s69, s68, 82432
  s_waitcnt lgkmcnt(6)
  buffer_store_dwordx4 v[36:39], v113, s[40:43], s69 offen sc1
  s_add_u32 s69, s68, 83456
  s_waitcnt lgkmcnt(5)
  buffer_store_dwordx4 v[40:43], v113, s[40:43], s69 offen sc1
  s_add_u32 s69, s68, 163840
  s_waitcnt lgkmcnt(4)
  buffer_store_dwordx4 v[44:47], v113, s[40:43], s69 offen sc1
  s_add_u32 s69, s68, 164864
  s_waitcnt lgkmcnt(3)
  buffer_store_dwordx4 v[48:51], v113, s[40:43], s69 offen sc1
  s_add_u32 s69, s68, 165888
  s_waitcnt lgkmcnt(2)
  buffer_store_dwordx4 v[52:55], v114, s[40:43], s69 offen
  s_add_u32 s69, s68, 246272
  s_waitcnt lgkmcnt(1)
  buffer_store_dwordx4 v[56:59], v113, s[40:43], s69 offen
  s_add_u32 s69, s68, 247296
  s_waitcnt lgkmcnt(0)
  buffer_store_dwordx4 v[60:63], v113, s[40:43], s69 offen
  s_endpgm
K1_EPIK:
  s_lshl_b32 s62, s49, 7
  s_lshl_b32 s63, s60, 6
  s_add_u32 s62, s62, s63
  s_and_b32 s63, s50, 3
  s_lshl_b32 s63, s63, 3
  s_lshl_b32 s68, s61, 2
  s_add_u32 s63, s63, s68
  s_mul_i32 s69, s48, 12288
  s_add_u32 s69, s69, 77824
  v_lshlrev_b32 v113, 4, v1
  v_add_u32 v112, s69, v113
  v_lshrrev_b32 v114, 5, v1
  s_mul_i32 s68, s63, 196608
  s_lshr_b32 s69, s62, 5
  s_mul_i32 s69, s69, 3072
  s_add_u32 s68, s68, s69
  s_add_u32 s68, s68, 5505024
  s_mul_i32 s69, s48, 12288
  s_add_u32 s69, s69, 77824
  v_mul_u32_u24 v115, 1536, v114
  v_and_b32 v116, 31, v1
  v_mul_u32_u24 v116, 48, v116
  v_add_u32 v115, v115, v116
  v_add_u32 v115, 40, v115
  v_add_u32 v115, s69, v115
  v_mov_b32 v140, 0x3f80
  v_mov_b32 v141, 0
  ds_write_b64 v115, v[140:141] offset:0
  ds_write_b64 v115, v[140:141] offset:3072
  ds_write_b64 v115, v[140:141] offset:6144
  ds_write_b64 v115, v[140:141] offset:9216
  v_mul_u32_u24 v114, 1536, v114
  v_add_u32 v114, v114, v113
  v_cvt_pk_bf16_f32 v120, v24, v25
  v_cvt_pk_bf16_f32 v121, v26, v27
  ds_write_b64 v17, v[120:121] offset:0
  v_cvt_pk_bf16_f32 v122, v28, v29
  v_cvt_pk_bf16_f32 v123, v30, v31
  ds_write_b64 v17, v[122:123] offset:768
  v_cvt_pk_bf16_f32 v124, v32, v33
  v_cvt_pk_bf16_f32 v125, v34, v35
  ds_write_b64 v17, v[124:125] offset:1536
  v_cvt_pk_bf16_f32 v126, v36, v37
  v_cvt_pk_bf16_f32 v127, v38, v39
  ds_write_b64 v17, v[126:127] offset:2304
  v_cvt_pk_bf16_f32 v128, v40, v41
  v_cvt_pk_bf16_f32 v129, v42, v43
  ds_write_b64 v18, v[128:129] offset:0
  v_cvt_pk_bf16_f32 v130, v44, v45
  v_cvt_pk_bf16_f32 v131, v46, v47
  ds_write_b64 v18, v[130:131] offset:768
  v_cvt_pk_bf16_f32 v132, v48, v49
  v_cvt_pk_bf16_f32 v133, v50, v51
  ds_write_b64 v18, v[132:133] offset:1536
  v_cvt_pk_bf16_f32 v134, v52, v53
  v_cvt_pk_bf16_f32 v135, v54, v55
  ds_write_b64 v18, v[134:135] offset:2304
  v_cvt_pk_bf16_f32 v120, v56, v57
  v_cvt_pk_bf16_f32 v121, v58, v59
  ds_write_b64 v19, v[120:121] offset:0
  v_cvt_pk_bf16_f32 v122, v60, v61
  v_cvt_pk_bf16_f32 v123, v62, v63
  ds_write_b64 v19, v[122:123] offset:768
  v_cvt_pk_bf16_f32 v124, v64, v65
  v_cvt_pk_bf16_f32 v125, v66, v67
  ds_write_b64 v19, v[124:125] offset:1536
  v_cvt_pk_bf16_f32 v126, v68, v69
  v_cvt_pk_bf16_f32 v127, v70, v71
  ds_write_b64 v19, v[126:127] offset:2304
  v_cvt_pk_bf16_f32 v128, v72, v73
  v_cvt_pk_bf16_f32 v129, v74, v75
  ds_write_b64 v20, v[128:129] offset:0
  v_cvt_pk_bf16_f32 v130, v76, v77
  v_cvt_pk_bf16_f32 v131, v78, v79
  ds_write_b64 v20, v[130:131] offset:768
  v_cvt_pk_bf16_f32 v132, v80, v81
  v_cvt_pk_bf16_f32 v133, v82, v83
  ds_write_b64 v20, v[132:133] offset:1536
  v_cvt_pk_bf16_f32 v134, v84, v85
  v_cvt_pk_bf16_f32 v135, v86, v87
  ds_write_b64 v20, v[134:135] offset:2304
  v_cvt_pk_bf16_f32 v120, v88, v89
  v_cvt_pk_bf16_f32 v121, v90, v91
  ds_write_b64 v21, v[120:121] offset:0
  v_cvt_pk_bf16_f32 v122, v92, v93
  v_cvt_pk_bf16_f32 v123, v94, v95
  ds_write_b64 v21, v[122:123] offset:768
  v_cvt_pk_bf16_f32 v124, v96, v97
  v_cvt_pk_bf16_f32 v125, v98, v99
  ds_write_b64 v21, v[124:125] offset:1536
  v_cvt_pk_bf16_f32 v126, v100, v101
  v_cvt_pk_bf16_f32 v127, v102, v103
  ds_write_b64 v21, v[126:127] offset:2304
  s_waitcnt lgkmcnt(0)
  ds_read_b128 v[24:27], v112 offset:0
  ds_read_b128 v[28:31], v112 offset:1024
  ds_read_b128 v[32:35], v112 offset:2048
  ds_read_b128 v[36:39], v112 offset:3072
  ds_read_b128 v[40:43], v112 offset:4096
  ds_read_b128 v[44:47], v112 offset:5120
  ds_read_b128 v[48:51], v112 offset:6144
  ds_read_b128 v[52:55], v112 offset:7168
  ds_read_b128 v[56:59], v112 offset:8192
  ds_read_b128 v[60:63], v112 offset:9216
  ds_read_b128 v[64:67], v112 offset:10240
  ds_read_b128 v[68:71], v112 offset:11264
  s_waitcnt lgkmcnt(11)
  buffer_store_dwordx4 v[24:27], v113, s[40:43], s68 offen offset:0 sc1
  s_waitcnt lgkmcnt(10)
  buffer_store_dwordx4 v[28:31], v114, s[40:43], s68 offen offset:1024 sc1
  s_waitcnt lgkmcnt(9)
  buffer_store_dwordx4 v[32:35], v113, s[40:43], s68 offen offset:3584 sc1
  s_add_u32 s68, s68, 196608
  s_waitcnt lgkmcnt(8)
  buffer_store_dwordx4 v[36:39], v113, s[40:43], s68 offen offset:0 sc1
  s_waitcnt lgkmcnt(7)
  buffer_store_dwordx4 v[40:43], v114, s[40:43], s68 offen offset:1024 sc1
  s_waitcnt lgkmcnt(6)
  buffer_store_dwordx4 v[44:47], v113, s[40:43], s68 offen offset:3584 sc1
  s_add_u32 s68, s68, 196608
  s_waitcnt lgkmcnt(5)
  buffer_store_dwordx4 v[48:51], v113, s[40:43], s68 offen offset:0 sc1
  s_waitcnt lgkmcnt(4)
  buffer_store_dwordx4 v[52:55], v114, s[40:43], s68 offen offset:1024
  s_waitcnt lgkmcnt(3)
  buffer_store_dwordx4 v[56:59], v113, s[40:43], s68 offen offset:3584
  s_add_u32 s68, s68, 196608
  s_waitcnt lgkmcnt(2)
  buffer_store_dwordx4 v[60:63], v113, s[40:43], s68 offen offset:0
  s_waitcnt lgkmcnt(1)
  buffer_store_dwordx4 v[64:67], v114, s[40:43], s68 offen offset:1024
  s_waitcnt lgkmcnt(0)
  buffer_store_dwordx4 v[68:71], v113, s[40:43], s68 offen offset:3584
  s_endpgm
K1_LOADER:
  s_sub_u32 s60, s48, 4
  v_lshrrev_b32 v3, 3, v1
  v_and_b32 v4, 7, v1
  v_xor_b32 v4, v4, v3
  v_lshlrev_b32 v4, 4, v4
  s_lshl_b32 s61, s60, 5
  v_add_u32 v3, s61, v3
  v_mul_u32_u24 v3, 1280, v3
  v_add_u32 v2, v3, v4
  s_lshl_b32 s62, s60, 12
  s_mov_b32 s66, 0
  s_mov_b32 s67, 0
  s_mov_b32 s68, 0
  s_mov_b32 s69, 0
  v_add_u32 v5, 0, v1
  v_mul_u32_u24 v6, 0xccd, v5
  v_lshrrev_b32 v6, 16, v6
  v_mul_u32_u24 v7, 20, v6
  v_sub_u32 v7, v5, v7
  v_lshrrev_b32 v8, 3, v6
  v_lshlrev_b32 v8, 1, v8
  v_xor_b32 v7, v7, v8
  v_lshlrev_b32 v7, 4, v7
  s_lshl_b32 s61, s60, 4
  v_add_u32 v6, s61, v6
  v_mul_lo_u32 v6, v6, s51
  v_add_u32 v10, v6, v7
  v_add_u32 v5, 64, v1
  v_mul_u32_u24 v6, 0xccd, v5
  v_lshrrev_b32 v6, 16, v6
  v_mul_u32_u24 v7, 20, v6
  v_sub_u32 v7, v5, v7
  v_lshrrev_b32 v8, 3, v6
  v_lshlrev_b32 v8, 1, v8
  v_xor_b32 v7, v7, v8
  v_lshlrev_b32 v7, 4, v7
  s_lshl_b32 s61, s60, 4
  v_add_u32 v6, s61, v6
  v_mul_lo_u32 v6, v6, s51
  v_add_u32 v11, v6, v7
  v_add_u32 v5, 128, v1
  v_mul_u32_u24 v6, 0xccd, v5
  v_lshrrev_b32 v6, 16, v6
  v_mul_u32_u24 v7, 20, v6
  v_sub_u32 v7, v5, v7
  v_lshrrev_b32 v8, 3, v6
  v_lshlrev_b32 v8, 1, v8
  v_xor_b32 v7, v7, v8
  v_lshlrev_b32 v7, 4, v7
  s_lshl_b32 s61, s60, 4
  v_add_u32 v6, s61, v6
  v_mul_lo_u32 v6, v6, s51
  v_add_u32 v12, v6, v7
  v_add_u32 v5, 192, v1
  v_mul_u32_u24 v6, 0xccd, v5
  v_lshrrev_b32 v6, 16, v6
  v_mul_u32_u24 v7, 20, v6
  v_sub_u32 v7, v5, v7
  v_lshrrev_b32 v8, 3, v6
  v_lshlrev_b32 v8, 1, v8
  v_xor_b32 v7, v7, v8
  v_lshlrev_b32 v7, 4, v7
  s_lshl_b32 s61, s60, 4
  v_add_u32 v6, s61, v6
  v_mul_lo_u32 v6, v6, s51
  v_add_u32 v13, v6, v7
  v_add_u32 v5, 256, v1
  v_mul_u32_u24 v6, 0xccd, v5
  v_lshrrev_b32 v6, 16, v6
  v_mul_u32_u24 v7, 20, v6
  v_sub_u32 v7, v5, v7
  v_lshrrev_b32 v8, 3, v6
  v_lshlrev_b32 v8, 1, v8
  v_xor_b32 v7, v7, v8
  v_lshlrev_b32 v7, 4, v7
  s_lshl_b32 s61, s60, 4
  v_add_u32 v6, s61, v6
  v_mul_lo_u32 v6, v6, s51
  v_add_u32 v14, v6, v7
  v_lshrrev_b32 v5, 1, v1
  s_lshl_b32 s61, s60, 4
  v_add_u32 v5, s61, v5
  v_mul_u32_u24 v5, 40, v5
  v_and_b32 v6, 1, v1
  v_lshl_add_u32 v15, v6, 4, v5
  s_mul_i32 s63, s60, 5120
  s_add_u32 s63, s63, 16384
  s_lshl_b32 s64, s60, 9
  s_add_u32 s64, s64, 36864
  s_lshl_b32 s65, s51, 6
  s_mov_b32 s75, 0x55555555
  s_and_b32 s74, s50, 3
  s_cmp_eq_u32 s74, 1
  s_cselect_b32 s74, s75, -1
  s_mov_b32 s75, 0
  s_waitcnt lgkmcnt(0)
  s_add_u32 s28, s4, s58
  s_addc_u32 s29, s5, 0
  s_and_b32 s29, s29, 0xffff
  s_mov_b32 s30, 163840
  s_mov_b32 s31, 0x20000
  s_add_u32 s71, s66, s62
  s_add_u32 m0, s71, 0
  s_add_u32 s70, s67, 0
  buffer_load_dwordx4 v2, s[28:31], s70 offen lds
  s_add_u32 s71, s66, s62
  s_add_u32 m0, s71, 1024
  s_add_u32 s70, s67, 10240
  buffer_load_dwordx4 v2, s[28:31], s70 offen lds
  s_add_u32 s71, s66, s62
  s_add_u32 m0, s71, 2048
  s_add_u32 s70, s67, 20480
  buffer_load_dwordx4 v2, s[28:31], s70 offen lds
  s_add_u32 s71, s66, s62
  s_add_u32 m0, s71, 3072
  s_add_u32 s70, s67, 30720
  buffer_load_dwordx4 v2, s[28:31], s70 offen lds
  s_cmp_lt_u32 s50, 4
  s_cselect_b32 s54, s6, s16
  s_cselect_b32 s55, s7, s17
  s_add_u32 s32, s54, s57
  s_addc_u32 s33, s55, 0
  s_and_b32 s33, s33, 0xffff
  s_mov_b32 s34, s59
  s_mov_b32 s35, 0x20000
  s_and_b32 s55, s50, 3
  s_cmp_lt_u32 s55, 2
  s_cselect_b32 s52, s8, s10
  s_cselect_b32 s53, s9, s11
  s_and_b32 s56, s50, 1
  s_lshl_b32 s56, s56, 5
  s_sub_u32 s55, 25600, s56
  s_add_u32 s36, s52, s56
  s_addc_u32 s37, s53, 0
  s_and_b32 s37, s37, 0xffff
  s_mov_b32 s38, s55
  s_mov_b32 s39, 0x20000
  s_add_u32 s71, s66, s63
  s_add_u32 m0, s71, 0
  s_nop 0
  buffer_load_dwordx4 v10, s[32:35], s68 offen lds
  s_add_u32 s71, s66, s63
  s_add_u32 m0, s71, 1024
  s_nop 0
  buffer_load_dwordx4 v11, s[32:35], s68 offen lds
  s_add_u32 s71, s66, s63
  s_add_u32 m0, s71, 2048
  s_nop 0
  buffer_load_dwordx4 v12, s[32:35], s68 offen lds
  s_add_u32 s71, s66, s63
  s_add_u32 m0, s71, 3072
  s_nop 0
  buffer_load_dwordx4 v13, s[32:35], s68 offen lds
  s_add_u32 s71, s66, s63
  s_add_u32 m0, s71, 4096
  s_nop 0
  buffer_load_dwordx4 v14, s[32:35], s68 offen lds
  s_add_u32 m0, s66, s64
  s_mov_b64 exec, s[74:75]
  buffer_load_dwordx4 v15, s[36:39], s69 offen lds
  s_mov_b64 exec, -1
  s_add_u32 s67, s67, 128
  s_add_u32 s68, s68, s65
  s_add_u32 s69, s69, 2560
  s_add_u32 s66, s66, 38912
  s_cmp_eq_u32 s66, 155648
  s_cselect_b32 s66, 0, s66
  s_mov_b32 s40, s26
  s_and_b32 s41, s27, 0xffff
  s_mov_b32 s42, 16777216
  s_mov_b32 s43, 0x20000
  s_mov_b32 s44, s20
  s_and_b32 s45, s21, 0xffff
  s_mov_b32 s46, 1280
  s_mov_b32 s47, 0x20000
  s_cmp_ge_u32 s60, 2
  s_cbranch_scc1 K1_LD_N
  s_and_b32 s76, s50, 3
  s_cmp_eq_u32 s76, 1
  s_cbranch_scc1 K1_LD_E1
  s_cmp_eq_u32 s76, 2
  s_cbranch_scc1 K1_LD_E2
  s_cmp_eq_u32 s76, 3
  s_cbranch_scc1 K1_LD_E3
K1_LD_E0:
  s_add_u32 s71, s66, s62
  s_add_u32 m0, s71, 0
  s_add_u32 s70, s67, 0
  buffer_load_dwordx4 v2, s[28:31], s70 offen lds
  s_add_u32 s71, s66, s62
  s_add_u32 m0, s71, 1024
  s_add_u32 s70, s67, 10240
  buffer_load_dwordx4 v2, s[28:31], s70 offen lds
  s_add_u32 s71, s66, s62
  s_add_u32 m0, s71, 2048
  s_add_u32 s70, s67, 20480
  buffer_load_dwordx4 v2, s[28:31], s70 offen lds
  s_add_u32 s71, s66, s62
  s_add_u32 m0, s71, 3072
  s_add_u32 s70, s67, 30720
  buffer_load_dwordx4 v2, s[28:31], s70 offen lds
  s_add_u32 s71, s66, s63
  s_add_u32 m0, s71, 0
  s_nop 0
  buffer_load_dwordx4 v10, s[32:35], s68 offen lds
  s_add_u32 s71, s66, s63
  s_add_u32 m0, s71, 1024
  s_nop 0
  buffer_load_dwordx4 v11, s[32:35], s68 offen lds
  s_add_u32 s71, s66, s63
  s_add_u32 m0, s71, 2048
  s_nop 0
  buffer_load_dwordx4 v12, s[32:35], s68 offen lds
  s_add_u32 s71, s66, s63
  s_add_u32 m0, s71, 3072
  s_nop 0
  buffer_load_dwordx4 v13, s[32:35], s68 offen lds
  s_add_u32 s71, s66, s63
  s_add_u32 m0, s71, 4096
  s_nop 0
  buffer_load_dwordx4 v14, s[32:35], s68 offen lds
  s_add_u32 m0, s66, s64
  s_mov_b64 exec, s[74:75]
  buffer_load_dwordx4 v15, s[36:39], s69 offen lds
  s_mov_b64 exec, -1
  s_add_u32 s67, s67, 128
  s_add_u32 s68, s68, s65
  s_add_u32 s69, s69, 2560
  s_add_u32 s66, s66, 38912
  s_cmp_eq_u32 s66, 155648
  s_cselect_b32 s66, 0, s66
  v_and_b32 v17, 15, v1
  v_lshrrev_b32 v18, 4, v1
  s_lshr_b32 s76, s50, 2
  s_lshl_b32 s76, s76, 5
  s_lshl_b32 s77, s60, 4
  s_add_u32 s76, s76, s77
  s_lshl_b32 s76, s76, 7
  v_lshlrev_b32 v20, 7, v17
  v_add_u32 v20, s76, v20
  v_and_b32 v19, 7, v17
  v_xor_b32 v19, v19, v18
  v_lshlrev_b32 v19, 4, v19
  v_add_u32 v20, v20, v19
  v_xor_b32 v21, 64, v20
  v_lshrrev_b32 v19, 2, v17
  v_lshl_add_u32 v19, v18, 3, v19
  v_lshlrev_b32 v22, 5, v19
  v_and_b32 v19, 3, v1
  v_lshl_add_u32 v22, v19, 3, v22
  v_add_u32 v22, 36864, v22
  v_lshlrev_b32 v23, 4, v18
  v_add_u32 v23, 155648, v23
  v_mov_b32 v44, 0
  v_mov_b32 v45, 0
  v_mov_b32 v46, 0
  v_mov_b32 v47, 0
  s_mov_b32 s76, 0
  s_mov_b32 s78, 0xff00ff00
  s_mov_b32 s79, 0xff00ff00
  s_waitcnt vmcnt(10)
  s_barrier
  v_add_u32 v24, s76, v20
  v_add_u32 v25, s76, v21
  v_add_u32 v26, s76, v22
  ds_read_b128 v[28:31], v24
  ds_read_b64_tr_b16 v[36:37], v26 offset:0
  ds_read_b64_tr_b16 v[38:39], v26 offset:128
  ds_read_b128 v[32:35], v25
  ds_read_b64_tr_b16 v[40:41], v26 offset:1024
  ds_read_b64_tr_b16 v[42:43], v26 offset:1152
  s_mov_b32 s72, 0
K1_LDP_E0:
  s_add_u32 s71, s66, s62
  s_add_u32 m0, s71, 0
  s_add_u32 s70, s67, 0
  buffer_load_dwordx4 v2, s[28:31], s70 offen lds
  s_add_u32 s71, s66, s62
  s_add_u32 m0, s71, 1024
  s_add_u32 s70, s67, 10240
  buffer_load_dwordx4 v2, s[28:31], s70 offen lds
  s_add_u32 s71, s66, s62
  s_add_u32 m0, s71, 2048
  s_add_u32 s70, s67, 20480
  buffer_load_dwordx4 v2, s[28:31], s70 offen lds
  s_add_u32 s71, s66, s62
  s_add_u32 m0, s71, 3072
  s_add_u32 s70, s67, 30720
  buffer_load_dwordx4 v2, s[28:31], s70 offen lds
  s_add_u32 s71, s66, s63
  s_add_u32 m0, s71, 0
  s_nop 0
  buffer_load_dwordx4 v10, s[32:35], s68 offen lds
  s_add_u32 s71, s66, s63
  s_add_u32 m0, s71, 1024
  s_nop 0
  buffer_load_dwordx4 v11, s[32:35], s68 offen lds
  s_add_u32 s71, s66, s63
  s_add_u32 m0, s71, 2048
  s_nop 0
  buffer_load_dwordx4 v12, s[32:35], s68 offen lds
  s_add_u32 s71, s66, s63
  s_add_u32 m0, s71, 3072
  s_nop 0
  buffer_load_dwordx4 v13, s[32:35], s68 offen lds
  s_add_u32 s71, s66, s63
  s_add_u32 m0, s71, 4096
  s_nop 0
  buffer_load_dwordx4 v14, s[32:35], s68 offen lds
  s_add_u32 m0, s66, s64
  s_mov_b64 exec, s[74:75]
  buffer_load_dwordx4 v15, s[36:39], s69 offen lds
  s_mov_b64 exec, -1
  s_add_u32 s67, s67, 128
  s_add_u32 s68, s68, s65
  s_add_u32 s69, s69, 2560
  s_add_u32 s66, s66, 38912
  s_cmp_eq_u32 s66, 155648
  s_cselect_b32 s66, 0, s66
  s_add_u32 s72, s72, 1
  s_cmp_lt_u32 s72, 2
  s_cbranch_scc1 K1_LDP_E0
  s_waitcnt lgkmcnt(0)
  v_mfma_f32_16x16x32_bf16 v[44:47], v[36:39], v[28:31], v[44:47]
  v_mfma_f32_16x16x32_bf16 v[44:47], v[40:43], v[32:35], v[44:47]
  s_add_u32 s76, s76, 38912
  s_cmp_eq_u32 s76, 155648
  s_cselect_b32 s76, 0, s76
  s_mov_b32 s72, 1
K1_LDM_E0:
  s_waitcnt vmcnt(20)
  s_barrier
  v_add_u32 v24, s76, v20
  v_add_u32 v25, s76, v21
  v_add_u32 v26, s76, v22
  ds_read_b128 v[28:31], v24
  ds_read_b64_tr_b16 v[36:37], v26 offset:0
  ds_read_b64_tr_b16 v[38:39], v26 offset:128
  ds_read_b128 v[32:35], v25
  ds_read_b64_tr_b16 v[40:41], v26 offset:1024
  ds_read_b64_tr_b16 v[42:43], v26 offset:1152
  s_add_u32 s71, s66, s62
  s_add_u32 m0, s71, 0
  s_add_u32 s70, s67, 0
  buffer_load_dwordx4 v2, s[28:31], s70 offen lds
  s_add_u32 s71, s66, s62
  s_add_u32 m0, s71, 1024
  s_add_u32 s70, s67, 10240
  buffer_load_dwordx4 v2, s[28:31], s70 offen lds
  s_add_u32 s71, s66, s62
  s_add_u32 m0, s71, 2048
  s_add_u32 s70, s67, 20480
  buffer_load_dwordx4 v2, s[28:31], s70 offen lds
  s_add_u32 s71, s66, s62
  s_add_u32 m0, s71, 3072
  s_add_u32 s70, s67, 30720
  buffer_load_dwordx4 v2, s[28:31], s70 offen lds
  s_add_u32 s71, s66, s63
  s_add_u32 m0, s71, 0
  s_nop 0
  buffer_load_dwordx4 v10, s[32:35], s68 offen lds
  s_add_u32 s71, s66, s63
  s_add_u32 m0, s71, 1024
  s_nop 0
  buffer_load_dwordx4 v11, s[32:35], s68 offen lds
  s_add_u32 s71, s66, s63
  s_add_u32 m0, s71, 2048
  s_nop 0
  buffer_load_dwordx4 v12, s[32:35], s68 offen lds
  s_add_u32 s71, s66, s63
  s_add_u32 m0, s71, 3072
  s_nop 0
  buffer_load_dwordx4 v13, s[32:35], s68 offen lds
  s_add_u32 s71, s66, s63
  s_add_u32 m0, s71, 4096
  s_nop 0
  buffer_load_dwordx4 v14, s[32:35], s68 offen lds
  s_add_u32 m0, s66, s64
  s_mov_b64 exec, s[74:75]
  buffer_load_dwordx4 v15, s[36:39], s69 offen lds
  s_mov_b64 exec, -1
  s_add_u32 s67, s67, 128
  s_add_u32 s68, s68, s65
  s_add_u32 s69, s69, 2560
  s_add_u32 s66, s66, 38912
  s_cmp_eq_u32 s66, 155648
  s_cselect_b32 s66, 0, s66
  s_waitcnt lgkmcnt(0)
  v_mfma_f32_16x16x32_bf16 v[44:47], v[36:39], v[28:31], v[44:47]
  v_mfma_f32_16x16x32_bf16 v[44:47], v[40:43], v[32:35], v[44:47]
  s_add_u32 s76, s76, 38912
  s_cmp_eq_u32 s76, 155648
  s_cselect_b32 s76, 0, s76
  s_add_u32 s72, s72, 1
  s_cmp_lt_u32 s72, 7
  s_cbranch_scc1 K1_LDM_E0
  s_waitcnt vmcnt(20)
  s_barrier
  v_add_u32 v24, s76, v20
  v_add_u32 v25, s76, v21
  v_add_u32 v26, s76, v22
  ds_read_b128 v[28:31], v24
  ds_read_b64_tr_b16 v[36:37], v26 offset:0
  ds_read_b64_tr_b16 v[38:39], v26 offset:128
  ds_read_b128 v[32:35], v25
  ds_read_b64_tr_b16 v[40:41], v26 offset:1024
  ds_read_b64_tr_b16 v[42:43], v26 offset:1152
  s_waitcnt lgkmcnt(0)
  v_mfma_f32_16x16x32_bf16 v[44:47], v[36:39], v[28:31], v[44:47]
  v_mfma_f32_16x16x32_bf16 v[44:47], v[40:43], v[32:35], v[44:47]
  s_add_u32 s76, s76, 38912
  s_cmp_eq_u32 s76, 155648
  s_cselect_b32 s76, 0, s76
  s_waitcnt vmcnt(10)
  s_barrier
  v_add_u32 v24, s76, v20
  v_add_u32 v25, s76, v21
  v_add_u32 v26, s76, v22
  ds_read_b128 v[28:31], v24
  ds_read_b64_tr_b16 v[36:37], v26 offset:0
  ds_read_b64_tr_b16 v[38:39], v26 offset:128
  ds_read_b128 v[32:35], v25
  ds_read_b64_tr_b16 v[40:41], v26 offset:1024
  ds_read_b64_tr_b16 v[42:43], v26 offset:1152
  s_waitcnt lgkmcnt(0)
  v_mfma_f32_16x16x32_bf16 v[44:47], v[36:39], v[28:31], v[44:47]
  v_mfma_f32_16x16x32_bf16 v[44:47], v[40:43], v[32:35], v[44:47]
  s_add_u32 s76, s76, 38912
  s_cmp_eq_u32 s76, 155648
  s_cselect_b32 s76, 0, s76
  s_waitcnt vmcnt(0)
  s_barrier
  v_add_u32 v24, s76, v20
  v_add_u32 v25, s76, v21
  v_add_u32 v26, s76, v22
  ds_read_b128 v[28:31], v24
  ds_read_b64_tr_b16 v[36:37], v26 offset:0
  ds_read_b64_tr_b16 v[38:39], v26 offset:128
  ds_read_b128 v[32:35], v25
  ds_read_b64_tr_b16 v[40:41], v26 offset:1024
  ds_read_b64_tr_b16 v[42:43], v26 offset:1152
  s_waitcnt lgkmcnt(0)
  v_mfma_f32_16x16x32_bf16 v[44:47], v[36:39], v[28:31], v[44:47]
  v_mfma_f32_16x16x32_bf16 v[44:47], v[40:43], v[32:35], v[44:47]
  s_add_u32 s76, s76, 38912
  s_cmp_eq_u32 s76, 155648
  s_cselect_b32 s76, 0, s76
  s_nop 7
  s_nop 1
  s_lshr_b32 s71, s50, 2
  s_lshl_b32 s72, s49, 2
  s_add_u32 s72, s72, s71
  s_lshl_b32 s71, s72, 5
  s_mul_i32 s72, s72, 3072
  s_add_u32 s72, s72, 5242880
  s_mul_i32 s73, s60, 768
  s_add_u32 s73, s72, s73
  v_mul_u32_u24 v19, 48, v17
  v_cvt_pk_bf16_f32 v48, v44, v45
  v_cvt_pk_bf16_f32 v49, v46, v47
  v_lshl_add_u32 v19, v18, 3, v19
  buffer_store_dwordx2 v[48:49], v19, s[40:43], s73 offen
  s_endpgm
K1_LD_E1:
  s_cmp_lg_u32 s60, 0
  s_cbranch_scc1 K1_LDG_E1
  v_lshlrev_b32 v16, 4, v1
  s_mov_b32 m0, 155648
  s_nop 0
  buffer_load_dwordx4 v16, s[44:47], 0 offen lds
  s_mov_b64 exec, 0xffff
  s_movk_i32 s70, 1024
  s_mov_b32 m0, 156672
  s_nop 0
  buffer_load_dwordx4 v16, s[44:47], s70 offen lds
  s_mov_b64 exec, -1
K1_LDG_E1:
  s_add_u32 s71, s66, s62
  s_add_u32 m0, s71, 0
  s_add_u32 s70, s67, 0
  buffer_load_dwordx4 v2, s[28:31], s70 offen lds
  s_add_u32 s71, s66, s62
  s_add_u32 m0, s71, 1024
  s_add_u32 s70, s67, 10240
  buffer_load_dwordx4 v2, s[28:31], s70 offen lds
  s_add_u32 s71, s66, s62
  s_add_u32 m0, s71, 2048
  s_add_u32 s70, s67, 20480
  buffer_load_dwordx4 v2, s[28:31], s70 offen lds
  s_add_u32 s71, s66, s62
  s_add_u32 m0, s71, 3072
  s_add_u32 s70, s67, 30720
  buffer_load_dwordx4 v2, s[28:31], s70 offen lds
  s_add_u32 s71, s66, s63
  s_add_u32 m0, s71, 0
  s_nop 0
  buffer_load_dwordx4 v10, s[32:35], s68 offen lds
  s_add_u32 s71, s66, s63
  s_add_u32 m0, s71, 1024
  s_nop 0
  buffer_load_dwordx4 v11, s[32:35], s68 offen lds
  s_add_u32 s71, s66, s63
  s_add_u32 m0, s71, 2048
  s_nop 0
  buffer_load_dwordx4 v12, s[32:35], s68 offen lds
  s_add_u32 s71, s66, s63
  s_add_u32 m0, s71, 3072
  s_nop 0
  buffer_load_dwordx4 v13, s[32:35], s68 offen lds
  s_add_u32 s71, s66, s63
  s_add_u32 m0, s71, 4096
  s_nop 0
  buffer_load_dwordx4 v14, s[32:35], s68 offen lds
  s_add_u32 m0, s66, s64
  s_mov_b64 exec, s[74:75]
  buffer_load_dwordx4 v15, s[36:39], s69 offen lds
  s_mov_b64 exec, -1
  s_add_u32 s67, s67, 128
  s_add_u32 s68, s68, s65
  s_add_u32 s69, s69, 2560
  s_add_u32 s66, s66, 38912
  s_cmp_eq_u32 s66, 155648
  s_cselect_b32 s66, 0, s66
  v_and_b32 v17, 15, v1
  v_lshrrev_b32 v18, 4, v1
  s_lshr_b32 s76, s50, 2
  s_lshl_b32 s76, s76, 5
  s_lshl_b32 s77, s60, 4
  s_add_u32 s76, s76, s77
  s_lshl_b32 s76, s76, 7
  v_lshlrev_b32 v20, 7, v17
  v_add_u32 v20, s76, v20
  v_and_b32 v19, 7, v17
  v_xor_b32 v19, v19, v18
  v_lshlrev_b32 v19, 4, v19
  v_add_u32 v20, v20, v19
  v_xor_b32 v21, 64, v20
  v_lshrrev_b32 v19, 2, v17
  v_lshl_add_u32 v19, v18, 3, v19
  v_lshlrev_b32 v22, 5, v19
  v_and_b32 v19, 3, v1
  v_lshl_add_u32 v22, v19, 3, v22
  v_add_u32 v22, 36864, v22
  v_lshlrev_b32 v23, 4, v18
  v_add_u32 v23, 155648, v23
  v_mov_b32 v44, 0
  v_mov_b32 v45, 0
  v_mov_b32 v46, 0
  v_mov_b32 v47, 0
  s_mov_b32 s76, 0
  s_mov_b32 s78, 0xff00ff00
  s_mov_b32 s79, 0xff00ff00
  s_waitcnt vmcnt(10)
  s_barrier
  v_add_u32 v24, s76, v20
  v_add_u32 v25, s76, v21
  v_add_u32 v26, s76, v22
  ds_read_b128 v[28:31], v24
  ds_read_b64_tr_b16 v[36:37], v26 offset:0
  ds_read_b64_tr_b16 v[38:39], v26 offset:128
  s_mov_b64 exec, s[78:79]
  ds_read_b128 v[36:39], v23 offset:0
  s_mov_b64 exec, -1
  ds_read_b128 v[32:35], v25
  ds_read_b64_tr_b16 v[40:41], v26 offset:1024
  ds_read_b64_tr_b16 v[42:43], v26 offset:1152
  s_mov_b64 exec, s[78:79]
  ds_read_b128 v[40:43], v23 offset:64
  s_mov_b64 exec, -1
  s_mov_b32 s72, 0
K1_LDP_E1:
  s_add_u32 s71, s66, s62
  s_add_u32 m0, s71, 0
  s_add_u32 s70, s67, 0
  buffer_load_dwordx4 v2, s[28:31], s70 offen lds
  s_add_u32 s71, s66, s62
  s_add_u32 m0, s71, 1024
  s_add_u32 s70, s67, 10240
  buffer_load_dwordx4 v2, s[28:31], s70 offen lds
  s_add_u32 s71, s66, s62
  s_add_u32 m0, s71, 2048
  s_add_u32 s70, s67, 20480
  buffer_load_dwordx4 v2, s[28:31], s70 offen lds
  s_add_u32 s71, s66, s62
  s_add_u32 m0, s71, 3072
  s_add_u32 s70, s67, 30720
  buffer_load_dwordx4 v2, s[28:31], s70 offen lds
  s_add_u32 s71, s66, s63
  s_add_u32 m0, s71, 0
  s_nop 0
  buffer_load_dwordx4 v10, s[32:35], s68 offen lds
  s_add_u32 s71, s66, s63
  s_add_u32 m0, s71, 1024
  s_nop 0
  buffer_load_dwordx4 v11, s[32:35], s68 offen lds
  s_add_u32 s71, s66, s63
  s_add_u32 m0, s71, 2048
  s_nop 0
  buffer_load_dwordx4 v12, s[32:35], s68 offen lds
  s_add_u32 s71, s66, s63
  s_add_u32 m0, s71, 3072
  s_nop 0
  buffer_load_dwordx4 v13, s[32:35], s68 offen lds
  s_add_u32 s71, s66, s63
  s_add_u32 m0, s71, 4096
  s_nop 0
  buffer_load_dwordx4 v14, s[32:35], s68 offen lds
  s_add_u32 m0, s66, s64
  s_mov_b64 exec, s[74:75]
  buffer_load_dwordx4 v15, s[36:39], s69 offen lds
  s_mov_b64 exec, -1
  s_add_u32 s67, s67, 128
  s_add_u32 s68, s68, s65
  s_add_u32 s69, s69, 2560
  s_add_u32 s66, s66, 38912
  s_cmp_eq_u32 s66, 155648
  s_cselect_b32 s66, 0, s66
  s_add_u32 s72, s72, 1
  s_cmp_lt_u32 s72, 2
  s_cbranch_scc1 K1_LDP_E1
  s_waitcnt lgkmcnt(0)
  v_mfma_f32_16x16x32_bf16 v[44:47], v[36:39], v[28:31], v[44:47]
  v_mfma_f32_16x16x32_bf16 v[44:47], v[40:43], v[32:35], v[44:47]
  s_add_u32 s76, s76, 38912
  s_cmp_eq_u32 s76, 155648
  s_cselect_b32 s76, 0, s76
  v_add_u32 v23, 128, v23
  s_mov_b32 s72, 1
K1_LDM_E1:
  s_waitcnt vmcnt(20)
  s_barrier
  v_add_u32 v24, s76, v20
  v_add_u32 v25, s76, v21
  v_add_u32 v26, s76, v22
  ds_read_b128 v[28:31], v24
  ds_read_b64_tr_b16 v[36:37], v26 offset:0
  ds_read_b64_tr_b16 v[38:39], v26 offset:128
  s_mov_b64 exec, s[78:79]
  ds_read_b128 v[36:39], v23 offset:0
  s_mov_b64 exec, -1
  ds_read_b128 v[32:35], v25
  ds_read_b64_tr_b16 v[40:41], v26 offset:1024
  ds_read_b64_tr_b16 v[42:43], v26 offset:1152
  s_mov_b64 exec, s[78:79]
  ds_read_b128 v[40:43], v23 offset:64
  s_mov_b64 exec, -1
  s_add_u32 s71, s66, s62
  s_add_u32 m0, s71, 0
  s_add_u32 s70, s67, 0
  buffer_load_dwordx4 v2, s[28:31], s70 offen lds
  s_add_u32 s71, s66, s62
  s_add_u32 m0, s71, 1024
  s_add_u32 s70, s67, 10240
  buffer_load_dwordx4 v2, s[28:31], s70 offen lds
  s_add_u32 s71, s66, s62
  s_add_u32 m0, s71, 2048
  s_add_u32 s70, s67, 20480
  buffer_load_dwordx4 v2, s[28:31], s70 offen lds
  s_add_u32 s71, s66, s62
  s_add_u32 m0, s71, 3072
  s_add_u32 s70, s67, 30720
  buffer_load_dwordx4 v2, s[28:31], s70 offen lds
  s_add_u32 s71, s66, s63
  s_add_u32 m0, s71, 0
  s_nop 0
  buffer_load_dwordx4 v10, s[32:35], s68 offen lds
  s_add_u32 s71, s66, s63
  s_add_u32 m0, s71, 1024
  s_nop 0
  buffer_load_dwordx4 v11, s[32:35], s68 offen lds
  s_add_u32 s71, s66, s63
  s_add_u32 m0, s71, 2048
  s_nop 0
  buffer_load_dwordx4 v12, s[32:35], s68 offen lds
  s_add_u32 s71, s66, s63
  s_add_u32 m0, s71, 3072
  s_nop 0
  buffer_load_dwordx4 v13, s[32:35], s68 offen lds
  s_add_u32 s71, s66, s63
  s_add_u32 m0, s71, 4096
  s_nop 0
  buffer_load_dwordx4 v14, s[32:35], s68 offen lds
  s_add_u32 m0, s66, s64
  s_mov_b64 exec, s[74:75]
  buffer_load_dwordx4 v15, s[36:39], s69 offen lds
  s_mov_b64 exec, -1
  s_add_u32 s67, s67, 128
  s_add_u32 s68, s68, s65
  s_add_u32 s69, s69, 2560
  s_add_u32 s66, s66, 38912
  s_cmp_eq_u32 s66, 155648
  s_cselect_b32 s66, 0, s66
  s_waitcnt lgkmcnt(0)
  v_mfma_f32_16x16x32_bf16 v[44:47], v[36:39], v[28:31], v[44:47]
  v_mfma_f32_16x16x32_bf16 v[44:47], v[40:43], v[32:35], v[44:47]
  s_add_u32 s76, s76, 38912
  s_cmp_eq_u32 s76, 155648
  s_cselect_b32 s76, 0, s76
  v_add_u32 v23, 128, v23
  s_add_u32 s72, s72, 1
  s_cmp_lt_u32 s72, 7
  s_cbranch_scc1 K1_LDM_E1
  s_waitcnt vmcnt(20)
  s_barrier
  v_add_u32 v24, s76, v20
  v_add_u32 v25, s76, v21
  v_add_u32 v26, s76, v22
  ds_read_b128 v[28:31], v24
  ds_read_b64_tr_b16 v[36:37], v26 offset:0
  ds_read_b64_tr_b16 v[38:39], v26 offset:128
  s_mov_b64 exec, s[78:79]
  ds_read_b128 v[36:39], v23 offset:0
  s_mov_b64 exec, -1
  ds_read_b128 v[32:35], v25
  ds_read_b64_tr_b16 v[40:41], v26 offset:1024
  ds_read_b64_tr_b16 v[42:43], v26 offset:1152
  s_mov_b64 exec, s[78:79]
  ds_read_b128 v[40:43], v23 offset:64
  s_mov_b64 exec, -1
  s_waitcnt lgkmcnt(0)
  v_mfma_f32_16x16x32_bf16 v[44:47], v[36:39], v[28:31], v[44:47]
  v_mfma_f32_16x16x32_bf16 v[44:47], v[40:43], v[32:35], v[44:47]
  s_add_u32 s76, s76, 38912
  s_cmp_eq_u32 s76, 155648
  s_cselect_b32 s76, 0, s76
  v_add_u32 v23, 128, v23
  s_waitcnt vmcnt(10)
  s_barrier
  v_add_u32 v24, s76, v20
  v_add_u32 v25, s76, v21
  v_add_u32 v26, s76, v22
  ds_read_b128 v[28:31], v24
  ds_read_b64_tr_b16 v[36:37], v26 offset:0
  ds_read_b64_tr_b16 v[38:39], v26 offset:128
  s_mov_b64 exec, s[78:79]
  ds_read_b128 v[36:39], v23 offset:0
  s_mov_b64 exec, -1
  ds_read_b128 v[32:35], v25
  ds_read_b64_tr_b16 v[40:41], v26 offset:1024
  ds_read_b64_tr_b16 v[42:43], v26 offset:1152
  s_mov_b64 exec, s[78:79]
  ds_read_b128 v[40:43], v23 offset:64
  s_mov_b64 exec, -1
  s_waitcnt lgkmcnt(0)
  v_mfma_f32_16x16x32_bf16 v[44:47], v[36:39], v[28:31], v[44:47]
  v_mfma_f32_16x16x32_bf16 v[44:47], v[40:43], v[32:35], v[44:47]
  s_add_u32 s76, s76, 38912
  s_cmp_eq_u32 s76, 155648
  s_cselect_b32 s76, 0, s76
  v_add_u32 v23, 128, v23
  s_waitcnt vmcnt(0)
  s_barrier
  v_add_u32 v24, s76, v20
  v_add_u32 v25, s76, v21
  v_add_u32 v26, s76, v22
  ds_read_b128 v[28:31], v24
  ds_read_b64_tr_b16 v[36:37], v26 offset:0
  ds_read_b64_tr_b16 v[38:39], v26 offset:128
  s_mov_b64 exec, s[78:79]
  ds_read_b128 v[36:39], v23 offset:0
  s_mov_b64 exec, -1
  ds_read_b128 v[32:35], v25
  ds_read_b64_tr_b16 v[40:41], v26 offset:1024
  ds_read_b64_tr_b16 v[42:43], v26 offset:1152
  s_mov_b64 exec, s[78:79]
  ds_read_b128 v[40:43], v23 offset:64
  s_mov_b64 exec, -1
  s_waitcnt lgkmcnt(0)
  v_mfma_f32_16x16x32_bf16 v[44:47], v[36:39], v[28:31], v[44:47]
  v_mfma_f32_16x16x32_bf16 v[44:47], v[40:43], v[32:35], v[44:47]
  s_add_u32 s76, s76, 38912
  s_cmp_eq_u32 s76, 155648
  s_cselect_b32 s76, 0, s76
  v_add_u32 v23, 128, v23
  s_nop 7
  s_nop 1
  s_lshr_b32 s71, s50, 2
  s_lshl_b32 s72, s49, 2
  s_add_u32 s72, s72, s71
  s_lshl_b32 s71, s72, 5
  s_mul_i32 s72, s72, 3072
  s_add_u32 s72, s72, 5242880
  s_mul_i32 s73, s60, 768
  s_add_u32 s73, s72, s73
  v_mul_u32_u24 v19, 48, v17
  v_cvt_pk_bf16_f32 v48, v44, v45
  v_cvt_pk_bf16_f32 v49, v46, v47
  v_add_u32 v19, 32, v19
  v_mov_b32 v50, 0x3f80
  v_mov_b32 v51, 0
  v_lshlrev_b32 v20, 2, v17
  s_lshl_b32 s74, s60, 4
  s_add_u32 s74, s74, s71
  s_lshl_b32 s74, s74, 2
  s_add_u32 s74, s74, 11796480
  s_mov_b64 exec, 0xffff
  buffer_store_dwordx4 v[48:51], v19, s[40:43], s73 offen
  s_mov_b32 exec_lo, 0
  s_mov_b32 exec_hi, 0xffff
  buffer_store_dword v44, v20, s[40:43], s74 offen
  s_mov_b64 exec, -1
  s_endpgm
K1_LD_E2:
  s_add_u32 s71, s66, s62
  s_add_u32 m0, s71, 0
  s_add_u32 s70, s67, 0
  buffer_load_dwordx4 v2, s[28:31], s70 offen lds
  s_add_u32 s71, s66, s62
  s_add_u32 m0, s71, 1024
  s_add_u32 s70, s67, 10240
  buffer_load_dwordx4 v2, s[28:31], s70 offen lds
  s_add_u32 s71, s66, s62
  s_add_u32 m0, s71, 2048
  s_add_u32 s70, s67, 20480
  buffer_load_dwordx4 v2, s[28:31], s70 offen lds
  s_add_u32 s71, s66, s62
  s_add_u32 m0, s71, 3072
  s_add_u32 s70, s67, 30720
  buffer_load_dwordx4 v2, s[28:31], s70 offen lds
  s_add_u32 s71, s66, s63
  s_add_u32 m0, s71, 0
  s_nop 0
  buffer_load_dwordx4 v10, s[32:35], s68 offen lds
  s_add_u32 s71, s66, s63
  s_add_u32 m0, s71, 1024
  s_nop 0
  buffer_load_dwordx4 v11, s[32:35], s68 offen lds
  s_add_u32 s71, s66, s63
  s_add_u32 m0, s71, 2048
  s_nop 0
  buffer_load_dwordx4 v12, s[32:35], s68 offen lds
  s_add_u32 s71, s66, s63
  s_add_u32 m0, s71, 3072
  s_nop 0
  buffer_load_dwordx4 v13, s[32:35], s68 offen lds
  s_add_u32 s71, s66, s63
  s_add_u32 m0, s71, 4096
  s_nop 0
  buffer_load_dwordx4 v14, s[32:35], s68 offen lds
  s_add_u32 m0, s66, s64
  s_mov_b64 exec, s[74:75]
  buffer_load_dwordx4 v15, s[36:39], s69 offen lds
  s_mov_b64 exec, -1
  s_add_u32 s67, s67, 128
  s_add_u32 s68, s68, s65
  s_add_u32 s69, s69, 2560
  s_add_u32 s66, s66, 38912
  s_cmp_eq_u32 s66, 155648
  s_cselect_b32 s66, 0, s66
  v_and_b32 v17, 15, v1
  v_lshrrev_b32 v18, 4, v1
  s_lshr_b32 s76, s50, 2
  s_lshl_b32 s76, s76, 5
  s_lshl_b32 s77, s60, 4
  s_add_u32 s76, s76, s77
  s_lshl_b32 s76, s76, 7
  v_lshlrev_b32 v20, 7, v17
  v_add_u32 v20, s76, v20
  v_and_b32 v19, 7, v17
  v_xor_b32 v19, v19, v18
  v_lshlrev_b32 v19, 4, v19
  v_add_u32 v20, v20, v19
  v_xor_b32 v21, 64, v20
  v_lshrrev_b32 v19, 2, v17
  v_lshl_add_u32 v19, v18, 3, v19
  v_lshlrev_b32 v22, 5, v19
  v_and_b32 v19, 3, v1
  v_lshl_add_u32 v22, v19, 3, v22
  v_add_u32 v22, 36864, v22
  v_lshlrev_b32 v23, 4, v18
  v_add_u32 v23, 155648, v23
  v_mov_b32 v44, 0
  v_mov_b32 v45, 0
  v_mov_b32 v46, 0
  v_mov_b32 v47, 0
  s_mov_b32 s76, 0
  s_mov_b32 s78, 0xff00ff00
  s_mov_b32 s79, 0xff00ff00
  s_waitcnt vmcnt(10)
  s_barrier
  v_add_u32 v24, s76, v20
  v_add_u32 v25, s76, v21
  v_add_u32 v26, s76, v22
  ds_read_b128 v[28:31], v24
  ds_read_b64_tr_b16 v[36:37], v26 offset:0
  ds_read_b64_tr_b16 v[38:39], v26 offset:128
  ds_read_b128 v[32:35], v25
  ds_read_b64_tr_b16 v[40:41], v26 offset:1024
  ds_read_b64_tr_b16 v[42:43], v26 offset:1152
  s_mov_b32 s72, 0
K1_LDP_E2:
  s_add_u32 s71, s66, s62
  s_add_u32 m0, s71, 0
  s_add_u32 s70, s67, 0
  buffer_load_dwordx4 v2, s[28:31], s70 offen lds
  s_add_u32 s71, s66, s62
  s_add_u32 m0, s71, 1024
  s_add_u32 s70, s67, 10240
  buffer_load_dwordx4 v2, s[28:31], s70 offen lds
  s_add_u32 s71, s66, s62
  s_add_u32 m0, s71, 2048
  s_add_u32 s70, s67, 20480
  buffer_load_dwordx4 v2, s[28:31], s70 offen lds
  s_add_u32 s71, s66, s62
  s_add_u32 m0, s71, 3072
  s_add_u32 s70, s67, 30720
  buffer_load_dwordx4 v2, s[28:31], s70 offen lds
  s_add_u32 s71, s66, s63
  s_add_u32 m0, s71, 0
  s_nop 0
  buffer_load_dwordx4 v10, s[32:35], s68 offen lds
  s_add_u32 s71, s66, s63
  s_add_u32 m0, s71, 1024
  s_nop 0
  buffer_load_dwordx4 v11, s[32:35], s68 offen lds
  s_add_u32 s71, s66, s63
  s_add_u32 m0, s71, 2048
  s_nop 0
  buffer_load_dwordx4 v12, s[32:35], s68 offen lds
  s_add_u32 s71, s66, s63
  s_add_u32 m0, s71, 3072
  s_nop 0
  buffer_load_dwordx4 v13, s[32:35], s68 offen lds
  s_add_u32 s71, s66, s63
  s_add_u32 m0, s71, 4096
  s_nop 0
  buffer_load_dwordx4 v14, s[32:35], s68 offen lds
  s_add_u32 m0, s66, s64
  s_mov_b64 exec, s[74:75]
  buffer_load_dwordx4 v15, s[36:39], s69 offen lds
  s_mov_b64 exec, -1
  s_add_u32 s67, s67, 128
  s_add_u32 s68, s68, s65
  s_add_u32 s69, s69, 2560
  s_add_u32 s66, s66, 38912
  s_cmp_eq_u32 s66, 155648
  s_cselect_b32 s66, 0, s66
  s_add_u32 s72, s72, 1
  s_cmp_lt_u32 s72, 2
  s_cbranch_scc1 K1_LDP_E2
  s_waitcnt lgkmcnt(0)
  v_mfma_f32_16x16x32_bf16 v[44:47], v[28:31], v[36:39], v[44:47]
  v_mfma_f32_16x16x32_bf16 v[44:47], v[32:35], v[40:43], v[44:47]
  s_add_u32 s76, s76, 38912
  s_cmp_eq_u32 s76, 155648
  s_cselect_b32 s76, 0, s76
  s_mov_b32 s72, 1
K1_LDM_E2:
  s_waitcnt vmcnt(20)
  s_barrier
  v_add_u32 v24, s76, v20
  v_add_u32 v25, s76, v21
  v_add_u32 v26, s76, v22
  ds_read_b128 v[28:31], v24
  ds_read_b64_tr_b16 v[36:37], v26 offset:0
  ds_read_b64_tr_b16 v[38:39], v26 offset:128
  ds_read_b128 v[32:35], v25
  ds_read_b64_tr_b16 v[40:41], v26 offset:1024
  ds_read_b64_tr_b16 v[42:43], v26 offset:1152
  s_add_u32 s71, s66, s62
  s_add_u32 m0, s71, 0
  s_add_u32 s70, s67, 0
  buffer_load_dwordx4 v2, s[28:31], s70 offen lds
  s_add_u32 s71, s66, s62
  s_add_u32 m0, s71, 1024
  s_add_u32 s70, s67, 10240
  buffer_load_dwordx4 v2, s[28:31], s70 offen lds
  s_add_u32 s71, s66, s62
  s_add_u32 m0, s71, 2048
  s_add_u32 s70, s67, 20480
  buffer_load_dwordx4 v2, s[28:31], s70 offen lds
  s_add_u32 s71, s66, s62
  s_add_u32 m0, s71, 3072
  s_add_u32 s70, s67, 30720
  buffer_load_dwordx4 v2, s[28:31], s70 offen lds
  s_add_u32 s71, s66, s63
  s_add_u32 m0, s71, 0
  s_nop 0
  buffer_load_dwordx4 v10, s[32:35], s68 offen lds
  s_add_u32 s71, s66, s63
  s_add_u32 m0, s71, 1024
  s_nop 0
  buffer_load_dwordx4 v11, s[32:35], s68 offen lds
  s_add_u32 s71, s66, s63
  s_add_u32 m0, s71, 2048
  s_nop 0
  buffer_load_dwordx4 v12, s[32:35], s68 offen lds
  s_add_u32 s71, s66, s63
  s_add_u32 m0, s71, 3072
  s_nop 0
  buffer_load_dwordx4 v13, s[32:35], s68 offen lds
  s_add_u32 s71, s66, s63
  s_add_u32 m0, s71, 4096
  s_nop 0
  buffer_load_dwordx4 v14, s[32:35], s68 offen lds
  s_add_u32 m0, s66, s64
  s_mov_b64 exec, s[74:75]
  buffer_load_dwordx4 v15, s[36:39], s69 offen lds
  s_mov_b64 exec, -1
  s_add_u32 s67, s67, 128
  s_add_u32 s68, s68, s65
  s_add_u32 s69, s69, 2560
  s_add_u32 s66, s66, 38912
  s_cmp_eq_u32 s66, 155648
  s_cselect_b32 s66, 0, s66
  s_waitcnt lgkmcnt(0)
  v_mfma_f32_16x16x32_bf16 v[44:47], v[28:31], v[36:39], v[44:47]
  v_mfma_f32_16x16x32_bf16 v[44:47], v[32:35], v[40:43], v[44:47]
  s_add_u32 s76, s76, 38912
  s_cmp_eq_u32 s76, 155648
  s_cselect_b32 s76, 0, s76
  s_add_u32 s72, s72, 1
  s_cmp_lt_u32 s72, 7
  s_cbranch_scc1 K1_LDM_E2
  s_waitcnt vmcnt(20)
  s_barrier
  v_add_u32 v24, s76, v20
  v_add_u32 v25, s76, v21
  v_add_u32 v26, s76, v22
  ds_read_b128 v[28:31], v24
  ds_read_b64_tr_b16 v[36:37], v26 offset:0
  ds_read_b64_tr_b16 v[38:39], v26 offset:128
  ds_read_b128 v[32:35], v25
  ds_read_b64_tr_b16 v[40:41], v26 offset:1024
  ds_read_b64_tr_b16 v[42:43], v26 offset:1152
  s_waitcnt lgkmcnt(0)
  v_mfma_f32_16x16x32_bf16 v[44:47], v[28:31], v[36:39], v[44:47]
  v_mfma_f32_16x16x32_bf16 v[44:47], v[32:35], v[40:43], v[44:47]
  s_add_u32 s76, s76, 38912
  s_cmp_eq_u32 s76, 155648
  s_cselect_b32 s76, 0, s76
  s_waitcnt vmcnt(10)
  s_barrier
  v_add_u32 v24, s76, v20
  v_add_u32 v25, s76, v21
  v_add_u32 v26, s76, v22
  ds_read_b128 v[28:31], v24
  ds_read_b64_tr_b16 v[36:37], v26 offset:0
  ds_read_b64_tr_b16 v[38:39], v26 offset:128
  ds_read_b128 v[32:35], v25
  ds_read_b64_tr_b16 v[40:41], v26 offset:1024
  ds_read_b64_tr_b16 v[42:43], v26 offset:1152
  s_waitcnt lgkmcnt(0)
  v_mfma_f32_16x16x32_bf16 v[44:47], v[28:31], v[36:39], v[44:47]
  v_mfma_f32_16x16x32_bf16 v[44:47], v[32:35], v[40:43], v[44:47]
  s_add_u32 s76, s76, 38912
  s_cmp_eq_u32 s76, 155648
  s_cselect_b32 s76, 0, s76
  s_waitcnt vmcnt(0)
  s_barrier
  v_add_u32 v24, s76, v20
  v_add_u32 v25, s76, v21
  v_add_u32 v26, s76, v22
  ds_read_b128 v[28:31], v24
  ds_read_b64_tr_b16 v[36:37], v26 offset:0
  ds_read_b64_tr_b16 v[38:39], v26 offset:128
  ds_read_b128 v[32:35], v25
  ds_read_b64_tr_b16 v[40:41], v26 offset:1024
  ds_read_b64_tr_b16 v[42:43], v26 offset:1152
  s_waitcnt lgkmcnt(0)
  v_mfma_f32_16x16x32_bf16 v[44:47], v[28:31], v[36:39], v[44:47]
  v_mfma_f32_16x16x32_bf16 v[44:47], v[32:35], v[40:43], v[44:47]
  s_add_u32 s76, s76, 38912
  s_cmp_eq_u32 s76, 155648
  s_cselect_b32 s76, 0, s76
  s_nop 7
  s_nop 1
  s_lshr_b32 s71, s50, 2
  s_lshl_b32 s72, s49, 2
  s_add_u32 s72, s72, s71
  s_lshl_b32 s71, s72, 5
  s_mul_i32 s72, s72, 3072
  s_add_u32 s72, s72, 5242880
  s_mul_i32 s73, s60, 768
  s_add_u32 s73, s72, s73
  v_and_b32 v19, 1, v18
  v_mul_u32_u24 v19, 384, v19
  v_lshrrev_b32 v20, 1, v18
  v_lshl_add_u32 v19, v20, 3, v19
  v_lshl_add_u32 v19, v17, 4, v19
  v_add_u32 v19, 1536, v19
  v_cvt_pk_bf16_f32 v48, v44, v45
  v_cvt_pk_bf16_f32 v49, v46, v47
  buffer_store_dwordx2 v[48:49], v19, s[40:43], s73 offen
  s_endpgm
K1_LD_E3:
  s_add_u32 s71, s66, s62
  s_add_u32 m0, s71, 0
  s_add_u32 s70, s67, 0
  buffer_load_dwordx4 v2, s[28:31], s70 offen lds
  s_add_u32 s71, s66, s62
  s_add_u32 m0, s71, 1024
  s_add_u32 s70, s67, 10240
  buffer_load_dwordx4 v2, s[28:31], s70 offen lds
  s_add_u32 s71, s66, s62
  s_add_u32 m0, s71, 2048
  s_add_u32 s70, s67, 20480
  buffer_load_dwordx4 v2, s[28:31], s70 offen lds
  s_add_u32 s71, s66, s62
  s_add_u32 m0, s71, 3072
  s_add_u32 s70, s67, 30720
  buffer_load_dwordx4 v2, s[28:31], s70 offen lds
  s_add_u32 s71, s66, s63
  s_add_u32 m0, s71, 0
  s_nop 0
  buffer_load_dwordx4 v10, s[32:35], s68 offen lds
  s_add_u32 s71, s66, s63
  s_add_u32 m0, s71, 1024
  s_nop 0
  buffer_load_dwordx4 v11, s[32:35], s68 offen lds
  s_add_u32 s71, s66, s63
  s_add_u32 m0, s71, 2048
  s_nop 0
  buffer_load_dwordx4 v12, s[32:35], s68 offen lds
  s_add_u32 s71, s66, s63
  s_add_u32 m0, s71, 3072
  s_nop 0
  buffer_load_dwordx4 v13, s[32:35], s68 offen lds
  s_add_u32 s71, s66, s63
  s_add_u32 m0, s71, 4096
  s_nop 0
  buffer_load_dwordx4 v14, s[32:35], s68 offen lds
  s_add_u32 m0, s66, s64
  s_mov_b64 exec, s[74:75]
  buffer_load_dwordx4 v15, s[36:39], s69 offen lds
  s_mov_b64 exec, -1
  s_add_u32 s67, s67, 128
  s_add_u32 s68, s68, s65
  s_add_u32 s69, s69, 2560
  s_add_u32 s66, s66, 38912
  s_cmp_eq_u32 s66, 155648
  s_cselect_b32 s66, 0, s66
  v_and_b32 v17, 15, v1
  v_lshrrev_b32 v18, 4, v1
  s_lshr_b32 s76, s50, 2
  s_lshl_b32 s76, s76, 5
  s_lshl_b32 s77, s60, 4
  s_add_u32 s76, s76, s77
  s_lshl_b32 s76, s76, 7
  v_lshlrev_b32 v20, 7, v17
  v_add_u32 v20, s76, v20
  v_and_b32 v19, 7, v17
  v_xor_b32 v19, v19, v18
  v_lshlrev_b32 v19, 4, v19
  v_add_u32 v20, v20, v19
  v_xor_b32 v21, 64, v20
  v_lshrrev_b32 v19, 2, v17
  v_lshl_add_u32 v19, v18, 3, v19
  v_lshlrev_b32 v22, 5, v19
  v_and_b32 v19, 3, v1
  v_lshl_add_u32 v22, v19, 3, v22
  v_add_u32 v22, 36864, v22
  v_lshlrev_b32 v23, 4, v18
  v_add_u32 v23, 155648, v23
  v_mov_b32 v44, 0
  v_mov_b32 v45, 0
  v_mov_b32 v46, 0
  v_mov_b32 v47, 0
  s_mov_b32 s76, 0
  s_mov_b32 s78, 0xff00ff00
  s_mov_b32 s79, 0xff00ff00
  s_waitcnt vmcnt(10)
  s_barrier
  v_add_u32 v24, s76, v20
  v_add_u32 v25, s76, v21
  v_add_u32 v26, s76, v22
  ds_read_b128 v[28:31], v24
  ds_read_b64_tr_b16 v[36:37], v26 offset:0
  ds_read_b64_tr_b16 v[38:39], v26 offset:128
  ds_read_b128 v[32:35], v25
  ds_read_b64_tr_b16 v[40:41], v26 offset:1024
  ds_read_b64_tr_b16 v[42:43], v26 offset:1152
  s_mov_b32 s72, 0
K1_LDP_E3:
  s_add_u32 s71, s66, s62
  s_add_u32 m0, s71, 0
  s_add_u32 s70, s67, 0
  buffer_load_dwordx4 v2, s[28:31], s70 offen lds
  s_add_u32 s71, s66, s62
  s_add_u32 m0, s71, 1024
  s_add_u32 s70, s67, 10240
  buffer_load_dwordx4 v2, s[28:31], s70 offen lds
  s_add_u32 s71, s66, s62
  s_add_u32 m0, s71, 2048
  s_add_u32 s70, s67, 20480
  buffer_load_dwordx4 v2, s[28:31], s70 offen lds
  s_add_u32 s71, s66, s62
  s_add_u32 m0, s71, 3072
  s_add_u32 s70, s67, 30720
  buffer_load_dwordx4 v2, s[28:31], s70 offen lds
  s_add_u32 s71, s66, s63
  s_add_u32 m0, s71, 0
  s_nop 0
  buffer_load_dwordx4 v10, s[32:35], s68 offen lds
  s_add_u32 s71, s66, s63
  s_add_u32 m0, s71, 1024
  s_nop 0
  buffer_load_dwordx4 v11, s[32:35], s68 offen lds
  s_add_u32 s71, s66, s63
  s_add_u32 m0, s71, 2048
  s_nop 0
  buffer_load_dwordx4 v12, s[32:35], s68 offen lds
  s_add_u32 s71, s66, s63
  s_add_u32 m0, s71, 3072
  s_nop 0
  buffer_load_dwordx4 v13, s[32:35], s68 offen lds
  s_add_u32 s71, s66, s63
  s_add_u32 m0, s71, 4096
  s_nop 0
  buffer_load_dwordx4 v14, s[32:35], s68 offen lds
  s_add_u32 m0, s66, s64
  s_mov_b64 exec, s[74:75]
  buffer_load_dwordx4 v15, s[36:39], s69 offen lds
  s_mov_b64 exec, -1
  s_add_u32 s67, s67, 128
  s_add_u32 s68, s68, s65
  s_add_u32 s69, s69, 2560
  s_add_u32 s66, s66, 38912
  s_cmp_eq_u32 s66, 155648
  s_cselect_b32 s66, 0, s66
  s_add_u32 s72, s72, 1
  s_cmp_lt_u32 s72, 2
  s_cbranch_scc1 K1_LDP_E3
  s_waitcnt lgkmcnt(0)
  v_mfma_f32_16x16x32_bf16 v[44:47], v[28:31], v[36:39], v[44:47]
  v_mfma_f32_16x16x32_bf16 v[44:47], v[32:35], v[40:43], v[44:47]
  s_add_u32 s76, s76, 38912
  s_cmp_eq_u32 s76, 155648
  s_cselect_b32 s76, 0, s76
  s_mov_b32 s72, 1
K1_LDM_E3:
  s_waitcnt vmcnt(20)
  s_barrier
  v_add_u32 v24, s76, v20
  v_add_u32 v25, s76, v21
  v_add_u32 v26, s76, v22
  ds_read_b128 v[28:31], v24
  ds_read_b64_tr_b16 v[36:37], v26 offset:0
  ds_read_b64_tr_b16 v[38:39], v26 offset:128
  ds_read_b128 v[32:35], v25
  ds_read_b64_tr_b16 v[40:41], v26 offset:1024
  ds_read_b64_tr_b16 v[42:43], v26 offset:1152
  s_add_u32 s71, s66, s62
  s_add_u32 m0, s71, 0
  s_add_u32 s70, s67, 0
  buffer_load_dwordx4 v2, s[28:31], s70 offen lds
  s_add_u32 s71, s66, s62
  s_add_u32 m0, s71, 1024
  s_add_u32 s70, s67, 10240
  buffer_load_dwordx4 v2, s[28:31], s70 offen lds
  s_add_u32 s71, s66, s62
  s_add_u32 m0, s71, 2048
  s_add_u32 s70, s67, 20480
  buffer_load_dwordx4 v2, s[28:31], s70 offen lds
  s_add_u32 s71, s66, s62
  s_add_u32 m0, s71, 3072
  s_add_u32 s70, s67, 30720
  buffer_load_dwordx4 v2, s[28:31], s70 offen lds
  s_add_u32 s71, s66, s63
  s_add_u32 m0, s71, 0
  s_nop 0
  buffer_load_dwordx4 v10, s[32:35], s68 offen lds
  s_add_u32 s71, s66, s63
  s_add_u32 m0, s71, 1024
  s_nop 0
  buffer_load_dwordx4 v11, s[32:35], s68 offen lds
  s_add_u32 s71, s66, s63
  s_add_u32 m0, s71, 2048
  s_nop 0
  buffer_load_dwordx4 v12, s[32:35], s68 offen lds
  s_add_u32 s71, s66, s63
  s_add_u32 m0, s71, 3072
  s_nop 0
  buffer_load_dwordx4 v13, s[32:35], s68 offen lds
  s_add_u32 s71, s66, s63
  s_add_u32 m0, s71, 4096
  s_nop 0
  buffer_load_dwordx4 v14, s[32:35], s68 offen lds
  s_add_u32 m0, s66, s64
  s_mov_b64 exec, s[74:75]
  buffer_load_dwordx4 v15, s[36:39], s69 offen lds
  s_mov_b64 exec, -1
  s_add_u32 s67, s67, 128
  s_add_u32 s68, s68, s65
  s_add_u32 s69, s69, 2560
  s_add_u32 s66, s66, 38912
  s_cmp_eq_u32 s66, 155648
  s_cselect_b32 s66, 0, s66
  s_waitcnt lgkmcnt(0)
  v_mfma_f32_16x16x32_bf16 v[44:47], v[28:31], v[36:39], v[44:47]
  v_mfma_f32_16x16x32_bf16 v[44:47], v[32:35], v[40:43], v[44:47]
  s_add_u32 s76, s76, 38912
  s_cmp_eq_u32 s76, 155648
  s_cselect_b32 s76, 0, s76
  s_add_u32 s72, s72, 1
  s_cmp_lt_u32 s72, 7
  s_cbranch_scc1 K1_LDM_E3
  s_waitcnt vmcnt(20)
  s_barrier
  v_add_u32 v24, s76, v20
  v_add_u32 v25, s76, v21
  v_add_u32 v26, s76, v22
  ds_read_b128 v[28:31], v24
  ds_read_b64_tr_b16 v[36:37], v26 offset:0
  ds_read_b64_tr_b16 v[38:39], v26 offset:128
  ds_read_b128 v[32:35], v25
  ds_read_b64_tr_b16 v[40:41], v26 offset:1024
  ds_read_b64_tr_b16 v[42:43], v26 offset:1152
  s_waitcnt lgkmcnt(0)
  v_mfma_f32_16x16x32_bf16 v[44:47], v[28:31], v[36:39], v[44:47]
  v_mfma_f32_16x16x32_bf16 v[44:47], v[32:35], v[40:43], v[44:47]
  s_add_u32 s76, s76, 38912
  s_cmp_eq_u32 s76, 155648
  s_cselect_b32 s76, 0, s76
  s_waitcnt vmcnt(10)
  s_barrier
  v_add_u32 v24, s76, v20
  v_add_u32 v25, s76, v21
  v_add_u32 v26, s76, v22
  ds_read_b128 v[28:31], v24
  ds_read_b64_tr_b16 v[36:37], v26 offset:0
  ds_read_b64_tr_b16 v[38:39], v26 offset:128
  ds_read_b128 v[32:35], v25
  ds_read_b64_tr_b16 v[40:41], v26 offset:1024
  ds_read_b64_tr_b16 v[42:43], v26 offset:1152
  s_waitcnt lgkmcnt(0)
  v_mfma_f32_16x16x32_bf16 v[44:47], v[28:31], v[36:39], v[44:47]
  v_mfma_f32_16x16x32_bf16 v[44:47], v[32:35], v[40:43], v[44:47]
  s_add_u32 s76, s76, 38912
  s_cmp_eq_u32 s76, 155648
  s_cselect_b32 s76, 0, s76
  s_waitcnt vmcnt(0)
  s_barrier
  v_add_u32 v24, s76, v20
  v_add_u32 v25, s76, v21
  v_add_u32 v26, s76, v22
  ds_read_b128 v[28:31], v24
  ds_read_b64_tr_b16 v[36:37], v26 offset:0
  ds_read_b64_tr_b16 v[38:39], v26 offset:128
  ds_read_b128 v[32:35], v25
  ds_read_b64_tr_b16 v[40:41], v26 offset:1024
  ds_read_b64_tr_b16 v[42:43], v26 offset:1152
  s_waitcnt lgkmcnt(0)
  v_mfma_f32_16x16x32_bf16 v[44:47], v[28:31], v[36:39], v[44:47]
  v_mfma_f32_16x16x32_bf16 v[44:47], v[32:35], v[40:43], v[44:47]
  s_add_u32 s76, s76, 38912
  s_cmp_eq_u32 s76, 155648
  s_cselect_b32 s76, 0, s76
  s_nop 7
  s_nop 1
  s_lshr_b32 s71, s50, 2
  s_lshl_b32 s72, s49, 2
  s_add_u32 s72, s72, s71
  s_lshl_b32 s71, s72, 5
  s_mul_i32 s72, s72, 3072
  s_add_u32 s72, s72, 5242880
  s_mul_i32 s73, s60, 768
  s_add_u32 s73, s72, s73
  v_and_b32 v19, 1, v18
  v_mul_u32_u24 v19, 384, v19
  v_lshrrev_b32 v20, 1, v18
  v_lshl_add_u32 v19, v20, 3, v19
  v_lshl_add_u32 v19, v17, 4, v19
  v_add_u32 v19, 1792, v19
  v_cvt_pk_bf16_f32 v48, v44, v45
  v_cvt_pk_bf16_f32 v49, v46, v47
  s_mov_b32 exec_lo, 0x000f000f
  s_mov_b32 exec_hi, 0x000f000f
  buffer_store_dwordx2 v[48:49], v19, s[40:43], s73 offen
  s_mov_b64 exec, -1
  v_lshrrev_b32 v19, 1, v1
  v_mul_u32_u24 v19, 384, v19
  v_and_b32 v20, 1, v1
  v_lshl_add_u32 v19, v20, 4, v19
  v_add_u32 v19, 1856, v19
  v_cmp_eq_u32 vcc, 0, v20
  v_mov_b32 v21, 0x3f803f80
  s_nop 0
  v_cndmask_b32 v52, 0, v21, vcc
  v_mov_b32 v53, v52
  v_mov_b32 v54, v52
  v_mov_b32 v55, v52
  s_mov_b64 exec, 0xf
  buffer_store_dwordx4 v[52:55], v19, s[40:43], s73 offen
  s_endpgm
K1_LD_N:
  s_add_u32 s71, s66, s62
  s_add_u32 m0, s71, 0
  s_add_u32 s70, s67, 0
  buffer_load_dwordx4 v2, s[28:31], s70 offen lds
  s_add_u32 s71, s66, s62
  s_add_u32 m0, s71, 1024
  s_add_u32 s70, s67, 10240
  buffer_load_dwordx4 v2, s[28:31], s70 offen lds
  s_add_u32 s71, s66, s62
  s_add_u32 m0, s71, 2048
  s_add_u32 s70, s67, 20480
  buffer_load_dwordx4 v2, s[28:31], s70 offen lds
  s_add_u32 s71, s66, s62
  s_add_u32 m0, s71, 3072
  s_add_u32 s70, s67, 30720
  buffer_load_dwordx4 v2, s[28:31], s70 offen lds
  s_add_u32 s71, s66, s63
  s_add_u32 m0, s71, 0
  s_nop 0
  buffer_load_dwordx4 v10, s[32:35], s68 offen lds
  s_add_u32 s71, s66, s63
  s_add_u32 m0, s71, 1024
  s_nop 0
  buffer_load_dwordx4 v11, s[32:35], s68 offen lds
  s_add_u32 s71, s66, s63
  s_add_u32 m0, s71, 2048
  s_nop 0
  buffer_load_dwordx4 v12, s[32:35], s68 offen lds
  s_add_u32 s71, s66, s63
  s_add_u32 m0, s71, 3072
  s_nop 0
  buffer_load_dwordx4 v13, s[32:35], s68 offen lds
  s_add_u32 s71, s66, s63
  s_add_u32 m0, s71, 4096
  s_nop 0
  buffer_load_dwordx4 v14, s[32:35], s68 offen lds
  s_add_u32 m0, s66, s64
  s_mov_b64 exec, s[74:75]
  buffer_load_dwordx4 v15, s[36:39], s69 offen lds
  s_mov_b64 exec, -1
  s_add_u32 s67, s67, 128
  s_add_u32 s68, s68, s65
  s_add_u32 s69, s69, 2560
  s_add_u32 s66, s66, 38912
  s_cmp_eq_u32 s66, 155648
  s_cselect_b32 s66, 0, s66
  s_waitcnt vmcnt(10)
  s_barrier
  s_mov_b32 s72, 0
K1_LDP_N:
  s_add_u32 s71, s66, s62
  s_add_u32 m0, s71, 0
  s_add_u32 s70, s67, 0
  buffer_load_dwordx4 v2, s[28:31], s70 offen lds
  s_add_u32 s71, s66, s62
  s_add_u32 m0, s71, 1024
  s_add_u32 s70, s67, 10240
  buffer_load_dwordx4 v2, s[28:31], s70 offen lds
  s_add_u32 s71, s66, s62
  s_add_u32 m0, s71, 2048
  s_add_u32 s70, s67, 20480
  buffer_load_dwordx4 v2, s[28:31], s70 offen lds
  s_add_u32 s71, s66, s62
  s_add_u32 m0, s71, 3072
  s_add_u32 s70, s67, 30720
  buffer_load_dwordx4 v2, s[28:31], s70 offen lds
  s_add_u32 s71, s66, s63
  s_add_u32 m0, s71, 0
  s_nop 0
  buffer_load_dwordx4 v10, s[32:35], s68 offen lds
  s_add_u32 s71, s66, s63
  s_add_u32 m0, s71, 1024
  s_nop 0
  buffer_load_dwordx4 v11, s[32:35], s68 offen lds
  s_add_u32 s71, s66, s63
  s_add_u32 m0, s71, 2048
  s_nop 0
  buffer_load_dwordx4 v12, s[32:35], s68 offen lds
  s_add_u32 s71, s66, s63
  s_add_u32 m0, s71, 3072
  s_nop 0
  buffer_load_dwordx4 v13, s[32:35], s68 offen lds
  s_add_u32 s71, s66, s63
  s_add_u32 m0, s71, 4096
  s_nop 0
  buffer_load_dwordx4 v14, s[32:35], s68 offen lds
  s_add_u32 m0, s66, s64
  s_mov_b64 exec, s[74:75]
  buffer_load_dwordx4 v15, s[36:39], s69 offen lds
  s_mov_b64 exec, -1
  s_add_u32 s67, s67, 128
  s_add_u32 s68, s68, s65
  s_add_u32 s69, s69, 2560
  s_add_u32 s66, s66, 38912
  s_cmp_eq_u32 s66, 155648
  s_cselect_b32 s66, 0, s66
  s_add_u32 s72, s72, 1
  s_cmp_lt_u32 s72, 2
  s_cbranch_scc1 K1_LDP_N
  s_mov_b32 s72, 1
K1_LDM_N:
  s_waitcnt vmcnt(20)
  s_barrier
  s_add_u32 s71, s66, s62
  s_add_u32 m0, s71, 0
  s_add_u32 s70, s67, 0
  buffer_load_dwordx4 v2, s[28:31], s70 offen lds
  s_add_u32 s71, s66, s62
  s_add_u32 m0, s71, 1024
  s_add_u32 s70, s67, 10240
  buffer_load_dwordx4 v2, s[28:31], s70 offen lds
  s_add_u32 s71, s66, s62
  s_add_u32 m0, s71, 2048
  s_add_u32 s70, s67, 20480
  buffer_load_dwordx4 v2, s[28:31], s70 offen lds
  s_add_u32 s71, s66, s62
  s_add_u32 m0, s71, 3072
  s_add_u32 s70, s67, 30720
  buffer_load_dwordx4 v2, s[28:31], s70 offen lds
  s_add_u32 s71, s66, s63
  s_add_u32 m0, s71, 0
  s_nop 0
  buffer_load_dwordx4 v10, s[32:35], s68 offen lds
  s_add_u32 s71, s66, s63
  s_add_u32 m0, s71, 1024
  s_nop 0
  buffer_load_dwordx4 v11, s[32:35], s68 offen lds
  s_add_u32 s71, s66, s63
  s_add_u32 m0, s71, 2048
  s_nop 0
  buffer_load_dwordx4 v12, s[32:35], s68 offen lds
  s_add_u32 s71, s66, s63
  s_add_u32 m0, s71, 3072
  s_nop 0
  buffer_load_dwordx4 v13, s[32:35], s68 offen lds
  s_add_u32 s71, s66, s63
  s_add_u32 m0, s71, 4096
  s_nop 0
  buffer_load_dwordx4 v14, s[32:35], s68 offen lds
  s_add_u32 m0, s66, s64
  s_mov_b64 exec, s[74:75]
  buffer_load_dwordx4 v15, s[36:39], s69 offen lds
  s_mov_b64 exec, -1
  s_add_u32 s67, s67, 128
  s_add_u32 s68, s68, s65
  s_add_u32 s69, s69, 2560
  s_add_u32 s66, s66, 38912
  s_cmp_eq_u32 s66, 155648
  s_cselect_b32 s66, 0, s66
  s_add_u32 s72, s72, 1
  s_cmp_lt_u32 s72, 7
  s_cbranch_scc1 K1_LDM_N
  s_waitcnt vmcnt(20)
  s_barrier
  s_waitcnt vmcnt(10)
  s_barrier
  s_waitcnt vmcnt(0)
  s_barrier
  s_endpgm
K1_END:
  s_endpgm
  .globl k2_kernel
  .p2align 8
  .type k2_kernel,@function
k2_kernel:
  s_cmp_ge_u32 s2, 256
  s_cbranch_scc1 K2_END
  s_load_dwordx2 s[26:27], s[0:1], 88
  v_lshrrev_b32 v2, 6, v0
  v_and_b32 v1, 63, v0
  s_and_b32 s49, s2, 7
  s_lshr_b32 s50, s2, 3
  v_readfirstlane_b32 s48, v2
  s_mul_i32 s55, s50, 196608
  s_add_u32 s55, s55, 5505024
  s_cmp_ge_u32 s48, 8
  s_cbranch_scc1 K2_LOADER
  v_and_b32 v2, 31, v1
  v_lshrrev_b32 v3, 5, v1
  v_mul_u32_u24 v20, 48, v2
  v_add_u32 v21, 32, v20
  v_lshl_add_u32 v20, v3, 4, v20
  s_mov_b64 exec, 0xffffffff
  s_not_b64 exec, exec
  v_mov_b32 v21, 1872
  s_mov_b64 exec, -1
  s_lshl_b32 s52, s49, 8
  s_lshl_b32 s53, s48, 5
  s_add_u32 s52, s52, s53
  v_add_u32 v152, s52, v2
  v_mul_u32_u24 v152, 40, v152
  v_lshl_add_u32 v153, v3, 4, v152
  s_mul_i32 s54, s50, 81920
  v_mov_b32 v8, 0
  v_mov_b32 v9, 0
  v_mov_b32 v10, 0
  v_mov_b32 v11, 0
  v_mov_b32 v16, 0
  v_mov_b32 v17, 0
  v_mov_b32 v18, 0
  v_mov_b32 v19, 0
  s_waitcnt lgkmcnt(0)
  s_add_u32 s28, s26, 5242880
  s_addc_u32 s29, s27, 0
  s_and_b32 s29, s29, 0xffff
  s_mov_b32 s30, 196608
  s_mov_b32 s31, 0x20000
  s_mov_b32 s36, s26
  s_and_b32 s37, s27, 0xffff
  s_mov_b32 s38, 5242880
  s_mov_b32 s39, 0x20000
  buffer_load_dwordx4 v[28:31], v20, s[28:31], 0 offen
  buffer_load_dwordx4 v[32:35], v21, s[28:31], 0 offen
  buffer_load_dwordx4 v[4:7], v153, s[36:39], s54 offen
  s_mov_b64 exec, 0xffffffff
  buffer_load_dwordx2 v[8:9], v152, s[36:39], s54 offen offset:32
  s_mov_b64 exec, -1
  s_add_u32 s54, s54, 2621440
  buffer_load_dwordx4 v[12:15], v153, s[36:39], s54 offen
  s_mov_b64 exec, 0xffffffff
  buffer_load_dwordx2 v[16:17], v152, s[36:39], s54 offen offset:32
  s_mov_b64 exec, -1
  s_add_u32 s32, s26, s55
  s_addc_u32 s33, s27, 0
  s_and_b32 s33, s33, 0xffff
  s_mov_b32 s34, 196608
  s_mov_b32 s35, 0x20000
  s_add_u32 s40, s26, 11862016
  s_addc_u32 s41, s27, 0
  s_and_b32 s41, s41, 0xffff
  s_mov_b32 s42, 5242880
  s_mov_b32 s43, 0x20000
  v_min_u32 v154, 21, v2
  v_mul_u32_u24 v155, 384, v3
  v_lshl_add_u32 v22, v154, 4, v155
  v_add_u32 v22, 1536, v22
  v_mov_b32 v23, v20
  v_mov_b32 v24, v21
  v_mov_b32 v25, v22
  v_lshlrev_b32 v154, 2, v3
  v_sub_u32 v154, v2, v154
  s_mov_b32 s64, 0xf149f2ca
  v_subrev_u32 v155, 0, v154
  v_ashrrev_i32 v155, 31, v155
  v_and_b32 v120, s64, v155
  v_xor_b32 v136, s64, v120
  v_subrev_u32 v155, 1, v154
  v_ashrrev_i32 v155, 31, v155
  v_and_b32 v121, s64, v155
  v_xor_b32 v137, s64, v121
  v_subrev_u32 v155, 2, v154
  v_ashrrev_i32 v155, 31, v155
  v_and_b32 v122, s64, v155
  v_xor_b32 v138, s64, v122
  v_subrev_u32 v155, 3, v154
  v_ashrrev_i32 v155, 31, v155
  v_and_b32 v123, s64, v155
  v_xor_b32 v139, s64, v123
  v_subrev_u32 v155, 8, v154
  v_ashrrev_i32 v155, 31, v155
  v_and_b32 v124, s64, v155
  v_xor_b32 v140, s64, v124
  v_subrev_u32 v155, 9, v154
  v_ashrrev_i32 v155, 31, v155
  v_and_b32 v125, s64, v155
  v_xor_b32 v141, s64, v125
  v_subrev_u32 v155, 10, v154
  v_ashrrev_i32 v155, 31, v155
  v_and_b32 v126, s64, v155
  v_xor_b32 v142, s64, v126
  v_subrev_u32 v155, 11, v154
  v_ashrrev_i32 v155, 31, v155
  v_and_b32 v127, s64, v155
  v_xor_b32 v143, s64, v127
  v_subrev_u32 v155, 16, v154
  v_ashrrev_i32 v155, 31, v155
  v_and_b32 v128, s64, v155
  v_xor_b32 v144, s64, v128
  v_subrev_u32 v155, 17, v154
  v_ashrrev_i32 v155, 31, v155
  v_and_b32 v129, s64, v155
  v_xor_b32 v145, s64, v129
  v_subrev_u32 v155, 18, v154
  v_ashrrev_i32 v155, 31, v155
  v_and_b32 v130, s64, v155
  v_xor_b32 v146, s64, v130
  v_subrev_u32 v155, 19, v154
  v_ashrrev_i32 v155, 31, v155
  v_and_b32 v131, s64, v155
  v_xor_b32 v147, s64, v131
  v_subrev_u32 v155, 24, v154
  v_ashrrev_i32 v155, 31, v155
  v_and_b32 v132, s64, v155
  v_xor_b32 v148, s64, v132
  v_subrev_u32 v155, 25, v154
  v_ashrrev_i32 v155, 31, v155
  v_and_b32 v133, s64, v155
  v_xor_b32 v149, s64, v133
  v_subrev_u32 v155, 26, v154
  v_ashrrev_i32 v155, 31, v155
  v_and_b32 v134, s64, v155
  v_xor_b32 v150, s64, v134
  v_subrev_u32 v155, 27, v154
  v_ashrrev_i32 v155, 31, v155
  v_and_b32 v135, s64, v155
  v_xor_b32 v151, s64, v135
  v_mov_b32 v104, 0
  v_mov_b32 v105, 0
  v_mov_b32 v106, 0
  v_mov_b32 v107, 0
  v_mov_b32 v108, 0
  v_mov_b32 v109, 0
  v_mov_b32 v110, 0
  v_mov_b32 v111, 0
  v_mov_b32 v112, 0
  v_mov_b32 v113, 0
  v_mov_b32 v114, 0
  v_mov_b32 v115, 0
  v_mov_b32 v116, 0
  v_mov_b32 v117, 0
  v_mov_b32 v118, 0
  v_mov_b32 v119, 0
  v_mov_b32 v92, 0
  v_mov_b32 v93, 0
  v_mov_b32 v94, 0
  v_mov_b32 v95, 0
  v_mov_b32 v100, 0
  v_mov_b32 v101, 0
  v_mov_b32 v56, 0
  v_mov_b32 v57, 0
  v_mov_b32 v58, 0
  v_mov_b32 v59, 0
  s_waitcnt vmcnt(2)
  v_mfma_f32_32x32x16_bf16 v[64:79], v[28:31], v[4:7], 0
  v_mfma_f32_32x32x16_bf16 v[64:79], v[32:35], v[8:11], v[64:79]
  s_nop 7
  s_nop 7
  v_max3_f32 v152, v64, v65, v66
  v_max3_f32 v153, v67, v68, v69
  v_max3_f32 v152, v152, v70, v71
  v_max3_f32 v153, v153, v72, v73
  v_max3_f32 v152, v152, v74, v75
  v_max3_f32 v153, v153, v76, v77
  v_max3_f32 v152, v152, v78, v79
  s_nop 0
  v_max_f32 v152, v152, v153
  s_nop 0
  v_mov_b32 v153, v152
  s_nop 1
  v_permlane32_swap_b32 v152, v153
  s_nop 1
  v_max_f32 v152, v152, v153
  v_add_f32 v152, 0x42200000, v152
  v_sub_f32 v152, 0, v152
  v_mov_b32 v153, 0
  v_cvt_pk_bf16_f32 v152, v152, v153
  s_mov_b64 exec, 0xffffffff
  v_mov_b32 v10, v152
  s_mov_b64 exec, -1
  s_nop 1
  v_mfma_f32_32x32x16_bf16 v[64:79], v[28:31], v[4:7], 0
  v_mfma_f32_32x32x16_bf16 v[64:79], v[32:35], v[8:11], v[64:79]
  s_barrier
  ds_read_b128 v[36:39], v23 offset:3072
  ds_read_b128 v[40:43], v24 offset:3072
  ds_read_b128 v[44:47], v25 offset:0
  ds_read_b128 v[48:51], v25 offset:768
  ds_read_b128 v[28:31], v23 offset:6144
  ds_read_b128 v[32:35], v24 offset:6144
  s_mov_b32 s58, 0
  s_mov_b32 s59, 0
  s_nop 7
  s_waitcnt lgkmcnt(4)
  .p2align 6
  s_nop 0
K2_ALOOP:
  v_exp_f32 v64, v64
  v_exp_f32 v65, v65
  v_cvt_pk_bf16_f32 v102, v92, v93
  v_exp_f32 v66, v66
  v_exp_f32 v67, v67
  v_cvt_pk_bf16_f32 v103, v94, v95
  v_mfma_f32_32x32x16_bf16 v[80:95], v[36:39], v[4:7], 0
  v_exp_f32 v68, v68
  v_exp_f32 v69, v69
  v_cvt_pk_bf16_f32 v96, v64, v65
  v_exp_f32 v70, v70
  v_exp_f32 v71, v71
  v_cvt_pk_bf16_f32 v97, v66, v67
  v_mfma_f32_32x32x16_bf16 v[80:95], v[40:43], v[8:11], v[80:95]
  v_exp_f32 v72, v72
  v_exp_f32 v73, v73
  v_cvt_pk_bf16_f32 v98, v68, v69
  v_exp_f32 v74, v74
  v_exp_f32 v75, v75
  v_cvt_pk_bf16_f32 v99, v70, v71
  v_mfma_f32_32x32x16_bf16 v[104:119], v[56:59], v[100:103], v[104:119]
  v_exp_f32 v76, v76
  v_exp_f32 v77, v77
  v_cvt_pk_bf16_f32 v100, v72, v73
  s_waitcnt lgkmcnt(0)
  s_setprio 2
  ds_read_b128 v[52:55], v25 offset:3072
  ds_read_b128 v[56:59], v25 offset:3840
  ds_read_b128 v[36:39], v23 offset:9216
  ds_read_b128 v[40:43], v24 offset:9216
  v_exp_f32 v78, v78
  v_exp_f32 v79, v79
  v_cvt_pk_bf16_f32 v101, v74, v75
  v_mfma_f32_32x32x16_bf16 v[104:119], v[44:47], v[96:99], v[104:119]
  v_exp_f32 v80, v80
  v_exp_f32 v81, v81
  v_cvt_pk_bf16_f32 v102, v76, v77
  v_exp_f32 v82, v82
  v_exp_f32 v83, v83
  v_cvt_pk_bf16_f32 v103, v78, v79
  v_mfma_f32_32x32x16_bf16 v[64:79], v[28:31], v[4:7], 0
  v_exp_f32 v84, v84
  v_exp_f32 v85, v85
  v_cvt_pk_bf16_f32 v96, v80, v81
  v_exp_f32 v86, v86
  v_exp_f32 v87, v87
  v_cvt_pk_bf16_f32 v97, v82, v83
  v_mfma_f32_32x32x16_bf16 v[64:79], v[32:35], v[8:11], v[64:79]
  v_exp_f32 v88, v88
  v_exp_f32 v89, v89
  v_cvt_pk_bf16_f32 v98, v84, v85
  v_exp_f32 v90, v90
  v_exp_f32 v91, v91
  v_cvt_pk_bf16_f32 v99, v86, v87
  v_mfma_f32_32x32x16_bf16 v[104:119], v[48:51], v[100:103], v[104:119]
  v_exp_f32 v92, v92
  v_exp_f32 v93, v93
  v_cvt_pk_bf16_f32 v100, v88, v89
  s_waitcnt lgkmcnt(0)
  ds_read_b128 v[44:47], v25 offset:6144
  ds_read_b128 v[48:51], v25 offset:6912
  ds_read_b128 v[28:31], v23 offset:12288
  ds_read_b128 v[32:35], v24 offset:12288
  v_exp_f32 v94, v94
  v_exp_f32 v95, v95
  v_cvt_pk_bf16_f32 v101, v90, v91
  v_mfma_f32_32x32x16_bf16 v[104:119], v[52:55], v[96:99], v[104:119]
  v_exp_f32 v64, v64
  v_exp_f32 v65, v65
  v_cvt_pk_bf16_f32 v102, v92, v93
  v_exp_f32 v66, v66
  v_exp_f32 v67, v67
  v_cvt_pk_bf16_f32 v103, v94, v95
  v_mfma_f32_32x32x16_bf16 v[80:95], v[36:39], v[4:7], 0
  v_exp_f32 v68, v68
  v_exp_f32 v69, v69
  v_cvt_pk_bf16_f32 v96, v64, v65
  v_exp_f32 v70, v70
  v_exp_f32 v71, v71
  v_cvt_pk_bf16_f32 v97, v66, v67
  v_mfma_f32_32x32x16_bf16 v[80:95], v[40:43], v[8:11], v[80:95]
  v_exp_f32 v72, v72
  v_exp_f32 v73, v73
  v_cvt_pk_bf16_f32 v98, v68, v69
  v_exp_f32 v74, v74
  v_exp_f32 v75, v75
  v_cvt_pk_bf16_f32 v99, v70, v71
  v_mfma_f32_32x32x16_bf16 v[104:119], v[56:59], v[100:103], v[104:119]
  v_exp_f32 v76, v76
  v_exp_f32 v77, v77
  v_cvt_pk_bf16_f32 v100, v72, v73
  s_waitcnt lgkmcnt(0)
  s_setprio 1
  ds_read_b128 v[52:55], v25 offset:9216
  ds_read_b128 v[56:59], v25 offset:9984
  ds_read_b128 v[36:39], v23 offset:15360
  ds_read_b128 v[40:43], v24 offset:15360
  v_exp_f32 v78, v78
  v_exp_f32 v79, v79
  v_cvt_pk_bf16_f32 v101, v74, v75
  v_mfma_f32_32x32x16_bf16 v[104:119], v[44:47], v[96:99], v[104:119]
  v_exp_f32 v80, v80
  v_exp_f32 v81, v81
  v_cvt_pk_bf16_f32 v102, v76, v77
  v_exp_f32 v82, v82
  v_exp_f32 v83, v83
  v_cvt_pk_bf16_f32 v103, v78, v79
  v_mfma_f32_32x32x16_bf16 v[64:79], v[28:31], v[4:7], 0
  v_exp_f32 v84, v84
  v_exp_f32 v85, v85
  v_cvt_pk_bf16_f32 v96, v80, v81
  v_exp_f32 v86, v86
  v_exp_f32 v87, v87
  v_cvt_pk_bf16_f32 v97, v82, v83
  v_mfma_f32_32x32x16_bf16 v[64:79], v[32:35], v[8:11], v[64:79]
  v_exp_f32 v88, v88
  v_exp_f32 v89, v89
  v_cvt_pk_bf16_f32 v98, v84, v85
  v_exp_f32 v90, v90
  v_exp_f32 v91, v91
  v_cvt_pk_bf16_f32 v99, v86, v87
  v_mfma_f32_32x32x16_bf16 v[104:119], v[48:51], v[100:103], v[104:119]
  v_exp_f32 v92, v92
  v_exp_f32 v93, v93
  v_cvt_pk_bf16_f32 v100, v88, v89
  s_waitcnt lgkmcnt(0)
  ds_read_b128 v[44:47], v25 offset:12288
  ds_read_b128 v[48:51], v25 offset:13056
  ds_read_b128 v[28:31], v23 offset:18432
  ds_read_b128 v[32:35], v24 offset:18432
  v_exp_f32 v94, v94
  v_exp_f32 v95, v95
  v_cvt_pk_bf16_f32 v101, v90, v91
  v_mfma_f32_32x32x16_bf16 v[104:119], v[52:55], v[96:99], v[104:119]
  v_exp_f32 v64, v64
  v_exp_f32 v65, v65
  v_cvt_pk_bf16_f32 v102, v92, v93
  v_exp_f32 v66, v66
  v_exp_f32 v67, v67
  v_cvt_pk_bf16_f32 v103, v94, v95
  v_mfma_f32_32x32x16_bf16 v[80:95], v[36:39], v[4:7], 0
  v_exp_f32 v68, v68
  v_exp_f32 v69, v69
  v_cvt_pk_bf16_f32 v96, v64, v65
  v_exp_f32 v70, v70
  v_exp_f32 v71, v71
  v_cvt_pk_bf16_f32 v97, v66, v67
  v_mfma_f32_32x32x16_bf16 v[80:95], v[40:43], v[8:11], v[80:95]
  v_exp_f32 v72, v72
  v_exp_f32 v73, v73
  v_cvt_pk_bf16_f32 v98, v68, v69
  v_exp_f32 v74, v74
  v_exp_f32 v75, v75
  v_cvt_pk_bf16_f32 v99, v70, v71
  v_mfma_f32_32x32x16_bf16 v[104:119], v[56:59], v[100:103], v[104:119]
  v_exp_f32 v76, v76
  v_exp_f32 v77, v77
  v_cvt_pk_bf16_f32 v100, v72, v73
  s_waitcnt lgkmcnt(0)
  s_setprio 0
  ds_read_b128 v[52:55], v25 offset:15360
  ds_read_b128 v[56:59], v25 offset:16128
  ds_read_b128 v[36:39], v23 offset:21504
  ds_read_b128 v[40:43], v24 offset:21504
  v_exp_f32 v78, v78
  v_exp_f32 v79, v79
  v_cvt_pk_bf16_f32 v101, v74, v75
  v_mfma_f32_32x32x16_bf16 v[104:119], v[44:47], v[96:99], v[104:119]
  v_exp_f32 v80, v80
  v_exp_f32 v81, v81
  v_cvt_pk_bf16_f32 v102, v76, v77
  v_exp_f32 v82, v82
  v_exp_f32 v83, v83
  v_cvt_pk_bf16_f32 v103, v78, v79
  v_mfma_f32_32x32x16_bf16 v[64:79], v[28:31], v[4:7], 0
  v_exp_f32 v84, v84
  v_exp_f32 v85, v85
  v_cvt_pk_bf16_f32 v96, v80, v81
  v_exp_f32 v86, v86
  v_exp_f32 v87, v87
  v_cvt_pk_bf16_f32 v97, v82, v83
  v_mfma_f32_32x32x16_bf16 v[64:79], v[32:35], v[8:11], v[64:79]
  v_exp_f32 v88, v88
  v_exp_f32 v89, v89
  v_cvt_pk_bf16_f32 v98, v84, v85
  v_exp_f32 v90, v90
  v_exp_f32 v91, v91
  v_cvt_pk_bf16_f32 v99, v86, v87
  v_mfma_f32_32x32x16_bf16 v[104:119], v[48:51], v[100:103], v[104:119]
  v_exp_f32 v92, v92
  v_exp_f32 v93, v93
  v_cvt_pk_bf16_f32 v100, v88, v89
  s_waitcnt lgkmcnt(0)
  s_barrier
  s_add_u32 s59, s59, 24576
  s_cmp_eq_u32 s59, 98304
  s_cselect_b32 s59, 0, s59
  v_add_u32 v23, s59, v20
  v_add_u32 v24, s59, v21
  s_setprio 3
  ds_read_b128 v[44:47], v25 offset:18432
  ds_read_b128 v[48:51], v25 offset:19200
  ds_read_b128 v[28:31], v23 offset:0
  ds_read_b128 v[32:35], v24 offset:0
  v_exp_f32 v94, v94
  v_exp_f32 v95, v95
  v_cvt_pk_bf16_f32 v101, v90, v91
  v_mfma_f32_32x32x16_bf16 v[104:119], v[52:55], v[96:99], v[104:119]
  v_exp_f32 v64, v64
  v_exp_f32 v65, v65
  v_cvt_pk_bf16_f32 v102, v92, v93
  v_exp_f32 v66, v66
  v_exp_f32 v67, v67
  v_cvt_pk_bf16_f32 v103, v94, v95
  v_mfma_f32_32x32x16_bf16 v[80:95], v[36:39], v[4:7], 0
  v_exp_f32 v68, v68
  v_exp_f32 v69, v69
  v_cvt_pk_bf16_f32 v96, v64, v65
  v_exp_f32 v70, v70
  v_exp_f32 v71, v71
  v_cvt_pk_bf16_f32 v97, v66, v67
  v_mfma_f32_32x32x16_bf16 v[80:95], v[40:43], v[8:11], v[80:95]
  v_exp_f32 v72, v72
  v_exp_f32 v73, v73
  v_cvt_pk_bf16_f32 v98, v68, v69
  v_exp_f32 v74, v74
  v_exp_f32 v75, v75
  v_cvt_pk_bf16_f32 v99, v70, v71
  v_mfma_f32_32x32x16_bf16 v[104:119], v[56:59], v[100:103], v[104:119]
  v_exp_f32 v76, v76
  v_exp_f32 v77, v77
  v_cvt_pk_bf16_f32 v100, v72, v73
  s_waitcnt lgkmcnt(0)
  ds_read_b128 v[52:55], v25 offset:21504
  ds_read_b128 v[56:59], v25 offset:22272
  ds_read_b128 v[36:39], v23 offset:3072
  ds_read_b128 v[40:43], v24 offset:3072
  v_exp_f32 v78, v78
  v_exp_f32 v79, v79
  v_cvt_pk_bf16_f32 v101, v74, v75
  v_mfma_f32_32x32x16_bf16 v[104:119], v[44:47], v[96:99], v[104:119]
  v_exp_f32 v80, v80
  v_exp_f32 v81, v81
  v_cvt_pk_bf16_f32 v102, v76, v77
  v_exp_f32 v82, v82
  v_exp_f32 v83, v83
  v_cvt_pk_bf16_f32 v103, v78, v79
  v_mfma_f32_32x32x16_bf16 v[64:79], v[28:31], v[4:7], 0
  v_exp_f32 v84, v84
  v_exp_f32 v85, v85
  v_cvt_pk_bf16_f32 v96, v80, v81
  v_exp_f32 v86, v86
  v_exp_f32 v87, v87
  v_cvt_pk_bf16_f32 v97, v82, v83
  v_mfma_f32_32x32x16_bf16 v[64:79], v[32:35], v[8:11], v[64:79]
  v_exp_f32 v88, v88
  v_exp_f32 v89, v89
  v_cvt_pk_bf16_f32 v98, v84, v85
  v_exp_f32 v90, v90
  v_exp_f32 v91, v91
  v_cvt_pk_bf16_f32 v99, v86, v87
  v_mfma_f32_32x32x16_bf16 v[104:119], v[48:51], v[100:103], v[104:119]
  v_exp_f32 v92, v92
  v_exp_f32 v93, v93
  v_cvt_pk_bf16_f32 v100, v88, v89
  s_waitcnt lgkmcnt(0)
  v_add_u32 v25, s59, v22
  ds_read_b128 v[44:47], v25 offset:0
  ds_read_b128 v[48:51], v25 offset:768
  ds_read_b128 v[28:31], v23 offset:6144
  ds_read_b128 v[32:35], v24 offset:6144
  v_exp_f32 v94, v94
  v_exp_f32 v95, v95
  v_cvt_pk_bf16_f32 v101, v90, v91
  v_mfma_f32_32x32x16_bf16 v[104:119], v[52:55], v[96:99], v[104:119]
  s_add_u32 s58, s58, 1
  s_cmp_lt_u32 s58, 8
  s_cbranch_scc1 K2_ALOOP
  v_cvt_pk_bf16_f32 v102, v92, v93
  v_cvt_pk_bf16_f32 v103, v94, v95
  s_mul_i32 s59, s48, 3072
  s_add_u32 s59, s59, 98304
  v_add_u32 v23, s59, v20
  v_add_u32 v24, s59, v21
  v_add_u32 v25, s59, v22
  s_waitcnt vmcnt(0) lgkmcnt(0)
  ds_read_b128 v[28:31], v23 offset:24576
  ds_read_b128 v[32:35], v24 offset:24576
  v_mfma_f32_32x32x16_bf16 v[104:119], v[56:59], v[100:103], v[104:119]
  s_waitcnt lgkmcnt(0)
  v_mfma_f32_32x32x16_bf16 v[64:79], v[28:31], v[12:15], v[120:135]
  v_mfma_f32_32x32x16_bf16 v[64:79], v[32:35], v[16:19], v[64:79]
  ds_read_b128 v[36:39], v23 offset:0
  ds_read_b128 v[40:43], v24 offset:0
  ds_read_b128 v[44:47], v25 offset:24576
  ds_read_b128 v[48:51], v25 offset:25344
  s_nop 7
  s_nop 3
  v_mov_b32 v152, v112
  v_mov_b32 v153, v112
  s_nop 1
  v_permlane32_swap_b32 v152, v153
  s_nop 1
  v_pk_add_f32 v[154:155], v[104:105], v[106:107]
  v_pk_add_f32 v[156:157], v[108:109], v[110:111]
  v_pk_add_f32 v[158:159], v[112:113], v[114:115]
  v_pk_add_f32 v[154:155], v[154:155], v[156:157]
  v_add_f32 v158, v158, v153
  v_pk_add_f32 v[154:155], v[154:155], v[158:159]
  v_add_f32 v154, v154, v155
  s_movk_i32 s60, 0x207
  v_cmp_class_f32 vcc, v154, s60
  s_nop 4
  s_cbranch_vccnz K2_SLOWA
  v_rcp_f32 v153, v153
  s_nop 0
  v_pk_mul_f32 v[104:105], v[104:105], v[152:153] op_sel:[0,1] op_sel_hi:[1,1]
  v_pk_mul_f32 v[106:107], v[106:107], v[152:153] op_sel:[0,1] op_sel_hi:[1,1]
  v_pk_mul_f32 v[108:109], v[108:109], v[152:153] op_sel:[0,1] op_sel_hi:[1,1]
  v_pk_mul_f32 v[110:111], v[110:111], v[152:153] op_sel:[0,1] op_sel_hi:[1,1]
  v_pk_mul_f32 v[112:113], v[112:113], v[152:153] op_sel:[0,1] op_sel_hi:[1,1]
  v_pk_mul_f32 v[114:115], v[114:115], v[152:153] op_sel:[0,1] op_sel_hi:[1,1]
  v_cvt_pk_bf16_f32 v156, v104, v105
  v_cvt_pk_bf16_f32 v157, v106, v107
  v_cvt_pk_bf16_f32 v158, v108, v109
  v_cvt_pk_bf16_f32 v159, v110, v111
  v_cvt_pk_bf16_f32 v160, v112, v113
  v_cvt_pk_bf16_f32 v161, v114, v115
  v_add_u32 v154, s52, v2
  v_mul_u32_u24 v154, 2560, v154
  s_mul_i32 s60, s50, 40
  s_add_u32 s60, s60, 0
  v_lshl_add_u32 v155, v3, 4, v154
  v_permlane32_swap_b32 v156, v158
  v_permlane32_swap_b32 v157, v159
  s_nop 1
  buffer_store_dwordx4 v[156:159], v155, s[40:43], s60 offen
  s_mov_b64 exec, 0xffffffff
  buffer_store_dwordx2 v[160:161], v154, s[40:43], s60 offen offset:32
  s_mov_b64 exec, -1
K2_BMAX:
  v_max3_f32 v152, v64, v65, v66
  v_max3_f32 v153, v67, v68, v69
  v_max3_f32 v152, v152, v70, v71
  v_max3_f32 v153, v153, v72, v73
  v_max3_f32 v152, v152, v74, v75
  v_max3_f32 v153, v153, v76, v77
  v_max3_f32 v152, v152, v78, v79
  s_nop 0
  v_max_f32 v152, v152, v153
  s_nop 0
  v_mov_b32 v153, v152
  s_nop 1
  v_permlane32_swap_b32 v152, v153
  s_nop 1
  v_max_f32 v152, v152, v153
  v_add_f32 v152, 0x42200000, v152
  v_sub_f32 v152, 0, v152
  v_mov_b32 v153, 0xf149f2ca
  v_cvt_pk_bf16_f32 v152, v152, v153
  s_mov_b64 exec, 0xffffffff
  v_mov_b32 v18, v152
  s_mov_b64 exec, -1
  s_nop 1
  v_mfma_f32_32x32x16_bf16 v[64:79], v[28:31], v[12:15], v[120:135]
  v_mfma_f32_32x32x16_bf16 v[64:79], v[32:35], v[16:19], v[64:79]
  s_nop 7
  ds_read_b128 v[28:31], v23 offset:3072
  ds_read_b128 v[32:35], v24 offset:3072
  s_nop 5
  s_waitcnt lgkmcnt(2)
  v_exp_f32 v64, v64
  v_exp_f32 v65, v65
  v_exp_f32 v66, v66
  v_exp_f32 v67, v67
  v_mfma_f32_32x32x16_bf16 v[80:95], v[36:39], v[12:15], v[136:151]
  v_exp_f32 v68, v68
  v_exp_f32 v69, v69
  v_cvt_pk_bf16_f32 v96, v64, v65
  v_exp_f32 v70, v70
  v_exp_f32 v71, v71
  v_cvt_pk_bf16_f32 v97, v66, v67
  v_mfma_f32_32x32x16_bf16 v[80:95], v[40:43], v[16:19], v[80:95]
  v_exp_f32 v72, v72
  v_exp_f32 v73, v73
  v_cvt_pk_bf16_f32 v98, v68, v69
  v_exp_f32 v74, v74
  v_exp_f32 v75, v75
  v_cvt_pk_bf16_f32 v99, v70, v71
  v_exp_f32 v76, v76
  v_exp_f32 v77, v77
  v_cvt_pk_bf16_f32 v100, v72, v73
  s_waitcnt lgkmcnt(0)
  ds_read_b128 v[52:55], v25 offset:0
  ds_read_b128 v[56:59], v25 offset:768
  ds_read_b128 v[36:39], v23 offset:6144
  ds_read_b128 v[40:43], v24 offset:6144
  v_exp_f32 v78, v78
  v_exp_f32 v79, v79
  v_cvt_pk_bf16_f32 v101, v74, v75
  v_mfma_f32_32x32x16_bf16 v[104:119], v[44:47], v[96:99], 0
  v_exp_f32 v80, v80
  v_exp_f32 v81, v81
  v_cvt_pk_bf16_f32 v102, v76, v77
  v_exp_f32 v82, v82
  v_exp_f32 v83, v83
  v_cvt_pk_bf16_f32 v103, v78, v79
  v_mfma_f32_32x32x16_bf16 v[64:79], v[28:31], v[12:15], 0
  v_exp_f32 v84, v84
  v_exp_f32 v85, v85
  v_cvt_pk_bf16_f32 v96, v80, v81
  v_exp_f32 v86, v86
  v_exp_f32 v87, v87
  v_cvt_pk_bf16_f32 v97, v82, v83
  v_mfma_f32_32x32x16_bf16 v[64:79], v[32:35], v[16:19], v[64:79]
  v_exp_f32 v88, v88
  v_exp_f32 v89, v89
  v_cvt_pk_bf16_f32 v98, v84, v85
  v_exp_f32 v90, v90
  v_exp_f32 v91, v91
  v_cvt_pk_bf16_f32 v99, v86, v87
  v_mfma_f32_32x32x16_bf16 v[104:119], v[48:51], v[100:103], v[104:119]
  v_exp_f32 v92, v92
  v_exp_f32 v93, v93
  v_cvt_pk_bf16_f32 v100, v88, v89
  s_waitcnt lgkmcnt(0)
  ds_read_b128 v[44:47], v25 offset:3072
  ds_read_b128 v[48:51], v25 offset:3840
  ds_read_b128 v[28:31], v23 offset:9216
  ds_read_b128 v[32:35], v24 offset:9216
  v_exp_f32 v94, v94
  v_exp_f32 v95, v95
  v_cvt_pk_bf16_f32 v101, v90, v91
  v_mfma_f32_32x32x16_bf16 v[104:119], v[52:55], v[96:99], v[104:119]
  v_exp_f32 v64, v64
  v_exp_f32 v65, v65
  v_cvt_pk_bf16_f32 v102, v92, v93
  v_exp_f32 v66, v66
  v_exp_f32 v67, v67
  v_cvt_pk_bf16_f32 v103, v94, v95
  v_mfma_f32_32x32x16_bf16 v[80:95], v[36:39], v[12:15], 0
  v_exp_f32 v68, v68
  v_exp_f32 v69, v69
  v_cvt_pk_bf16_f32 v96, v64, v65
  v_exp_f32 v70, v70
  v_exp_f32 v71, v71
  v_cvt_pk_bf16_f32 v97, v66, v67
  v_mfma_f32_32x32x16_bf16 v[80:95], v[40:43], v[16:19], v[80:95]
  v_exp_f32 v72, v72
  v_exp_f32 v73, v73
  v_cvt_pk_bf16_f32 v98, v68, v69
  v_exp_f32 v74, v74
  v_exp_f32 v75, v75
  v_cvt_pk_bf16_f32 v99, v70, v71
  v_mfma_f32_32x32x16_bf16 v[104:119], v[56:59], v[100:103], v[104:119]
  v_exp_f32 v76, v76
  v_exp_f32 v77, v77
  v_cvt_pk_bf16_f32 v100, v72, v73
  s_waitcnt lgkmcnt(0)
  ds_read_b128 v[52:55], v25 offset:6144
  ds_read_b128 v[56:59], v25 offset:6912
  ds_read_b128 v[36:39], v23 offset:12288
  ds_read_b128 v[40:43], v24 offset:12288
  v_exp_f32 v78, v78
  v_exp_f32 v79, v79
  v_cvt_pk_bf16_f32 v101, v74, v75
  v_mfma_f32_32x32x16_bf16 v[104:119], v[44:47], v[96:99], v[104:119]
  s_cmp_lg_u32 s48, 0
  s_cbranch_scc1 K2_WBM
  s_cmp_ge_u32 s2, 8
  s_cbranch_scc1 K2_WBM
  buffer_wbl2 sc1
K2_WBM:
  v_exp_f32 v80, v80
  v_exp_f32 v81, v81
  v_cvt_pk_bf16_f32 v102, v76, v77
  v_exp_f32 v82, v82
  v_exp_f32 v83, v83
  v_cvt_pk_bf16_f32 v103, v78, v79
  v_mfma_f32_32x32x16_bf16 v[64:79], v[28:31], v[12:15], 0
  v_exp_f32 v84, v84
  v_exp_f32 v85, v85
  v_cvt_pk_bf16_f32 v96, v80, v81
  v_exp_f32 v86, v86
  v_exp_f32 v87, v87
  v_cvt_pk_bf16_f32 v97, v82, v83
  v_mfma_f32_32x32x16_bf16 v[64:79], v[32:35], v[16:19], v[64:79]
  v_exp_f32 v88, v88
  v_exp_f32 v89, v89
  v_cvt_pk_bf16_f32 v98, v84, v85
  v_exp_f32 v90, v90
  v_exp_f32 v91, v91
  v_cvt_pk_bf16_f32 v99, v86, v87
  v_mfma_f32_32x32x16_bf16 v[104:119], v[48:51], v[100:103], v[104:119]
  v_exp_f32 v92, v92
  v_exp_f32 v93, v93
  v_cvt_pk_bf16_f32 v100, v88, v89
  s_waitcnt lgkmcnt(0)
  ds_read_b128 v[44:47], v25 offset:9216
  ds_read_b128 v[48:51], v25 offset:9984
  ds_read_b128 v[28:31], v23 offset:15360
  ds_read_b128 v[32:35], v24 offset:15360
  v_exp_f32 v94, v94
  v_exp_f32 v95, v95
  v_cvt_pk_bf16_f32 v101, v90, v91
  v_mfma_f32_32x32x16_bf16 v[104:119], v[52:55], v[96:99], v[104:119]
  v_exp_f32 v64, v64
  v_exp_f32 v65, v65
  v_cvt_pk_bf16_f32 v102, v92, v93
  v_exp_f32 v66, v66
  v_exp_f32 v67, v67
  v_cvt_pk_bf16_f32 v103, v94, v95
  v_mfma_f32_32x32x16_bf16 v[80:95], v[36:39], v[12:15], 0
  v_exp_f32 v68, v68
  v_exp_f32 v69, v69
  v_cvt_pk_bf16_f32 v96, v64, v65
  v_exp_f32 v70, v70
  v_exp_f32 v71, v71
  v_cvt_pk_bf16_f32 v97, v66, v67
  v_mfma_f32_32x32x16_bf16 v[80:95], v[40:43], v[16:19], v[80:95]
  v_exp_f32 v72, v72
  v_exp_f32 v73, v73
  v_cvt_pk_bf16_f32 v98, v68, v69
  v_exp_f32 v74, v74
  v_exp_f32 v75, v75
  v_cvt_pk_bf16_f32 v99, v70, v71
  v_mfma_f32_32x32x16_bf16 v[104:119], v[56:59], v[100:103], v[104:119]
  v_exp_f32 v76, v76
  v_exp_f32 v77, v77
  v_cvt_pk_bf16_f32 v100, v72, v73
  s_waitcnt lgkmcnt(0)
  ds_read_b128 v[52:55], v25 offset:12288
  ds_read_b128 v[56:59], v25 offset:13056
  ds_read_b128 v[36:39], v23 offset:18432
  ds_read_b128 v[40:43], v24 offset:18432
  v_exp_f32 v78, v78
  v_exp_f32 v79, v79
  v_cvt_pk_bf16_f32 v101, v74, v75
  v_mfma_f32_32x32x16_bf16 v[104:119], v[44:47], v[96:99], v[104:119]
  v_exp_f32 v80, v80
  v_exp_f32 v81, v81
  v_cvt_pk_bf16_f32 v102, v76, v77
  v_exp_f32 v82, v82
  v_exp_f32 v83, v83
  v_cvt_pk_bf16_f32 v103, v78, v79
  v_mfma_f32_32x32x16_bf16 v[64:79], v[28:31], v[12:15], 0
  v_exp_f32 v84, v84
  v_exp_f32 v85, v85
  v_cvt_pk_bf16_f32 v96, v80, v81
  v_exp_f32 v86, v86
  v_exp_f32 v87, v87
  v_cvt_pk_bf16_f32 v97, v82, v83
  v_mfma_f32_32x32x16_bf16 v[64:79], v[32:35], v[16:19], v[64:79]
  v_exp_f32 v88, v88
  v_exp_f32 v89, v89
  v_cvt_pk_bf16_f32 v98, v84, v85
  v_exp_f32 v90, v90
  v_exp_f32 v91, v91
  v_cvt_pk_bf16_f32 v99, v86, v87
  v_mfma_f32_32x32x16_bf16 v[104:119], v[48:51], v[100:103], v[104:119]
  v_exp_f32 v92, v92
  v_exp_f32 v93, v93
  v_cvt_pk_bf16_f32 v100, v88, v89
  s_waitcnt lgkmcnt(0)
  ds_read_b128 v[44:47], v25 offset:15360
  ds_read_b128 v[48:51], v25 offset:16128
  ds_read_b128 v[28:31], v23 offset:21504
  ds_read_b128 v[32:35], v24 offset:21504
  v_exp_f32 v94, v94
  v_exp_f32 v95, v95
  v_cvt_pk_bf16_f32 v101, v90, v91
  v_mfma_f32_32x32x16_bf16 v[104:119], v[52:55], v[96:99], v[104:119]
  v_exp_f32 v64, v64
  v_exp_f32 v65, v65
  v_cvt_pk_bf16_f32 v102, v92, v93
  v_exp_f32 v66, v66
  v_exp_f32 v67, v67
  v_cvt_pk_bf16_f32 v103, v94, v95
  v_mfma_f32_32x32x16_bf16 v[80:95], v[36:39], v[12:15], 0
  v_exp_f32 v68, v68
  v_exp_f32 v69, v69
  v_cvt_pk_bf16_f32 v96, v64, v65
  v_exp_f32 v70, v70
  v_exp_f32 v71, v71
  v_cvt_pk_bf16_f32 v97, v66, v67
  v_mfma_f32_32x32x16_bf16 v[80:95], v[40:43], v[16:19], v[80:95]
  v_exp_f32 v72, v72
  v_exp_f32 v73, v73
  v_cvt_pk_bf16_f32 v98, v68, v69
  v_exp_f32 v74, v74
  v_exp_f32 v75, v75
  v_cvt_pk_bf16_f32 v99, v70, v71
  v_mfma_f32_32x32x16_bf16 v[104:119], v[56:59], v[100:103], v[104:119]
  v_exp_f32 v76, v76
  v_exp_f32 v77, v77
  v_cvt_pk_bf16_f32 v100, v72, v73
  s_waitcnt lgkmcnt(0)
  ds_read_b128 v[52:55], v25 offset:18432
  ds_read_b128 v[56:59], v25 offset:19200
  v_exp_f32 v78, v78
  v_exp_f32 v79, v79
  v_cvt_pk_bf16_f32 v101, v74, v75
  v_mfma_f32_32x32x16_bf16 v[104:119], v[44:47], v[96:99], v[104:119]
  v_exp_f32 v80, v80
  v_exp_f32 v81, v81
  v_cvt_pk_bf16_f32 v102, v76, v77
  v_exp_f32 v82, v82
  v_exp_f32 v83, v83
  v_cvt_pk_bf16_f32 v103, v78, v79
  v_mfma_f32_32x32x16_bf16 v[64:79], v[28:31], v[12:15], 0
  v_exp_f32 v84, v84
  v_exp_f32 v85, v85
  v_cvt_pk_bf16_f32 v96, v80, v81
  v_exp_f32 v86, v86
  v_exp_f32 v87, v87
  v_cvt_pk_bf16_f32 v97, v82, v83
  v_mfma_f32_32x32x16_bf16 v[64:79], v[32:35], v[16:19], v[64:79]
  v_exp_f32 v88, v88
  v_exp_f32 v89, v89
  v_cvt_pk_bf16_f32 v98, v84, v85
  v_exp_f32 v90, v90
  v_exp_f32 v91, v91
  v_cvt_pk_bf16_f32 v99, v86, v87
  v_mfma_f32_32x32x16_bf16 v[104:119], v[48:51], v[100:103], v[104:119]
  v_exp_f32 v92, v92
  v_exp_f32 v93, v93
  v_cvt_pk_bf16_f32 v100, v88, v89
  s_waitcnt lgkmcnt(0)
  ds_read_b128 v[44:47], v25 offset:21504
  ds_read_b128 v[48:51], v25 offset:22272
  v_exp_f32 v94, v94
  v_exp_f32 v95, v95
  v_cvt_pk_bf16_f32 v101, v90, v91
  v_mfma_f32_32x32x16_bf16 v[104:119], v[52:55], v[96:99], v[104:119]
  v_exp_f32 v64, v64
  v_exp_f32 v65, v65
  v_cvt_pk_bf16_f32 v102, v92, v93
  v_exp_f32 v66, v66
  v_exp_f32 v67, v67
  v_cvt_pk_bf16_f32 v103, v94, v95
  v_exp_f32 v68, v68
  v_exp_f32 v69, v69
  v_cvt_pk_bf16_f32 v96, v64, v65
  v_exp_f32 v70, v70
  v_exp_f32 v71, v71
  v_cvt_pk_bf16_f32 v97, v66, v67
  v_exp_f32 v72, v72
  v_exp_f32 v73, v73
  v_cvt_pk_bf16_f32 v98, v68, v69
  v_exp_f32 v74, v74
  v_exp_f32 v75, v75
  v_cvt_pk_bf16_f32 v99, v70, v71
  v_mfma_f32_32x32x16_bf16 v[104:119], v[56:59], v[100:103], v[104:119]
  v_exp_f32 v76, v76
  v_exp_f32 v77, v77
  v_cvt_pk_bf16_f32 v100, v72, v73
  s_waitcnt lgkmcnt(0)
  v_exp_f32 v78, v78
  v_exp_f32 v79, v79
  v_cvt_pk_bf16_f32 v101, v74, v75
  v_mfma_f32_32x32x16_bf16 v[104:119], v[44:47], v[96:99], v[104:119]
  v_cvt_pk_bf16_f32 v102, v76, v77
  v_cvt_pk_bf16_f32 v103, v78, v79
  s_nop 1
  v_mfma_f32_32x32x16_bf16 v[104:119], v[48:51], v[100:103], v[104:119]
  s_nop 7
  s_nop 3
  v_mov_b32 v152, v112
  v_mov_b32 v153, v112
  s_nop 1
  v_permlane32_swap_b32 v152, v153
  s_nop 1
  v_pk_add_f32 v[154:155], v[104:105], v[106:107]
  v_pk_add_f32 v[156:157], v[108:109], v[110:111]
  v_pk_add_f32 v[158:159], v[112:113], v[114:115]
  v_pk_add_f32 v[154:155], v[154:155], v[156:157]
  v_add_f32 v158, v158, v153
  v_pk_add_f32 v[154:155], v[154:155], v[158:159]
  v_add_f32 v154, v154, v155
  s_movk_i32 s60, 0x207
  v_cmp_class_f32 vcc, v154, s60
  s_nop 4
  s_cbranch_vccnz K2_SLOWB
  v_rcp_f32 v153, v153
  s_nop 0
  v_pk_mul_f32 v[104:105], v[104:105], v[152:153] op_sel:[0,1] op_sel_hi:[1,1]
  v_pk_mul_f32 v[106:107], v[106:107], v[152:153] op_sel:[0,1] op_sel_hi:[1,1]
  v_pk_mul_f32 v[108:109], v[108:109], v[152:153] op_sel:[0,1] op_sel_hi:[1,1]
  v_pk_mul_f32 v[110:111], v[110:111], v[152:153] op_sel:[0,1] op_sel_hi:[1,1]
  v_pk_mul_f32 v[112:113], v[112:113], v[152:153] op_sel:[0,1] op_sel_hi:[1,1]
  v_pk_mul_f32 v[114:115], v[114:115], v[152:153] op_sel:[0,1] op_sel_hi:[1,1]
  v_cvt_pk_bf16_f32 v156, v104, v105
  v_cvt_pk_bf16_f32 v157, v106, v107
  v_cvt_pk_bf16_f32 v158, v108, v109
  v_cvt_pk_bf16_f32 v159, v110, v111
  v_cvt_pk_bf16_f32 v160, v112, v113
  v_cvt_pk_bf16_f32 v161, v114, v115
  v_add_u32 v154, s52, v2
  v_mul_u32_u24 v154, 2560, v154
  s_mul_i32 s60, s50, 40
  s_add_u32 s60, s60, 1280
  v_lshl_add_u32 v155, v3, 4, v154
  v_permlane32_swap_b32 v156, v158
  v_permlane32_swap_b32 v157, v159
  s_nop 1
  buffer_store_dwordx4 v[156:159], v155, s[40:43], s60 offen
  s_mov_b64 exec, 0xffffffff
  buffer_store_dwordx2 v[160:161], v154, s[40:43], s60 offen offset:32
  s_mov_b64 exec, -1
  s_endpgm
K2_LOADER:
  s_setprio 3
  v_lshlrev_b32 v26, 4, v1
  s_waitcnt lgkmcnt(0)
  s_add_u32 s28, s26, 5242880
  s_addc_u32 s29, s27, 0
  s_and_b32 s29, s29, 0xffff
  s_mov_b32 s30, 196608
  s_mov_b32 s31, 0x20000
  s_add_u32 s32, s26, s55
  s_addc_u32 s33, s27, 0
  s_and_b32 s33, s33, 0xffff
  s_mov_b32 s34, 196608
  s_mov_b32 s35, 0x20000
  s_mov_b32 s60, 0
  s_mov_b32 s61, 0
  s_mov_b32 s62, 0
K2_LD0:
  s_mov_b32 m0, s61
  s_add_u32 s61, s61, 1024
  buffer_load_dwordx4 v26, s[28:31], s60 offen lds
  s_add_u32 s60, s60, 1024
  s_mov_b32 m0, s61
  s_add_u32 s61, s61, 1024
  buffer_load_dwordx4 v26, s[28:31], s60 offen lds
  s_add_u32 s60, s60, 1024
  s_mov_b32 m0, s61
  s_add_u32 s61, s61, 1024
  buffer_load_dwordx4 v26, s[28:31], s60 offen lds
  s_add_u32 s60, s60, 1024
  s_mov_b32 m0, s61
  s_add_u32 s61, s61, 1024
  buffer_load_dwordx4 v26, s[28:31], s60 offen lds
  s_add_u32 s60, s60, 1024
  s_add_u32 s62, s62, 4
  s_cmp_lt_u32 s62, 48
  s_cbranch_scc1 K2_LD0
  s_waitcnt vmcnt(24)
  s_barrier
  s_mov_b32 s62, 0
K2_LD1:
  s_mov_b32 m0, s61
  s_add_u32 s61, s61, 1024
  buffer_load_dwordx4 v26, s[28:31], s60 offen lds
  s_add_u32 s60, s60, 1024
  s_mov_b32 m0, s61
  s_add_u32 s61, s61, 1024
  buffer_load_dwordx4 v26, s[28:31], s60 offen lds
  s_add_u32 s60, s60, 1024
  s_mov_b32 m0, s61
  s_add_u32 s61, s61, 1024
  buffer_load_dwordx4 v26, s[28:31], s60 offen lds
  s_add_u32 s60, s60, 1024
  s_mov_b32 m0, s61
  s_add_u32 s61, s61, 1024
  buffer_load_dwordx4 v26, s[28:31], s60 offen lds
  s_add_u32 s60, s60, 1024
  s_add_u32 s62, s62, 4
  s_cmp_lt_u32 s62, 24
  s_cbranch_scc1 K2_LD1
  s_mov_b32 s58, 0
K2_LDL:
  s_waitcnt vmcnt(24)
  s_barrier
  s_cmp_eq_u32 s61, 98304
  s_cselect_b32 s61, 0, s61
  s_mov_b32 s62, 0
K2_LD2:
  s_mov_b32 m0, s61
  s_add_u32 s61, s61, 1024
  buffer_load_dwordx4 v26, s[28:31], s60 offen lds
  s_add_u32 s60, s60, 1024
  s_mov_b32 m0, s61
  s_add_u32 s61, s61, 1024
  buffer_load_dwordx4 v26, s[28:31], s60 offen lds
  s_add_u32 s60, s60, 1024
  s_mov_b32 m0, s61
  s_add_u32 s61, s61, 1024
  buffer_load_dwordx4 v26, s[28:31], s60 offen lds
  s_add_u32 s60, s60, 1024
  s_mov_b32 m0, s61
  s_add_u32 s61, s61, 1024
  buffer_load_dwordx4 v26, s[28:31], s60 offen lds
  s_add_u32 s60, s60, 1024
  s_add_u32 s62, s62, 4
  s_cmp_lt_u32 s62, 24
  s_cbranch_scc1 K2_LD2
  s_add_u32 s58, s58, 1
  s_cmp_lt_u32 s58, 5
  s_cbranch_scc1 K2_LDL
  s_waitcnt vmcnt(24)
  s_barrier
  s_cmp_eq_u32 s49, 0
  s_cbranch_scc1 K2_BFILL
  s_lshl_b32 s60, s49, 3
  s_sub_u32 s60, s60, 8
  s_mul_i32 s60, s60, 3072
  s_mov_b32 s61, 98304
  s_mov_b32 s62, 0
K2_LD3:
  s_mov_b32 m0, s61
  s_add_u32 s61, s61, 1024
  buffer_load_dwordx4 v26, s[32:35], s60 offen lds
  s_add_u32 s60, s60, 1024
  s_mov_b32 m0, s61
  s_add_u32 s61, s61, 1024
  buffer_load_dwordx4 v26, s[32:35], s60 offen lds
  s_add_u32 s60, s60, 1024
  s_mov_b32 m0, s61
  s_add_u32 s61, s61, 1024
  buffer_load_dwordx4 v26, s[32:35], s60 offen lds
  s_add_u32 s60, s60, 1024
  s_mov_b32 m0, s61
  s_add_u32 s61, s61, 1024
  buffer_load_dwordx4 v26, s[32:35], s60 offen lds
  s_add_u32 s60, s60, 1024
  s_add_u32 s62, s62, 4
  s_cmp_lt_u32 s62, 48
  s_cbranch_scc1 K2_LD3
  s_load_dwordx2 s[12:13], s[0:1], 32
  s_load_dwordx2 s[18:19], s[0:1], 56
  v_add_u32 v5, 0, v1
  v_mul_u32_u24 v6, 6554, v5
  v_lshrrev_b32 v6, 16, v6
  v_mul_u32_u24 v7, 10, v6
  v_sub_u32 v7, v5, v7
  v_lshlrev_b32 v7, 4, v7
  v_bfe_u32 v8, v6, 2, 2
  v_lshlrev_b32 v8, 3, v8
  v_bfe_u32 v9, v6, 4, 1
  v_lshl_add_u32 v8, v9, 2, v8
  v_and_b32 v6, 3, v6
  v_add_u32 v6, v6, v8
  v_mul_u32_u24 v6, 1280, v6
  v_add_u32 v10, v6, v7
  v_add_u32 v5, 64, v1
  v_mul_u32_u24 v6, 6554, v5
  v_lshrrev_b32 v6, 16, v6
  v_mul_u32_u24 v7, 10, v6
  v_sub_u32 v7, v5, v7
  v_lshlrev_b32 v7, 4, v7
  v_bfe_u32 v8, v6, 2, 2
  v_lshlrev_b32 v8, 3, v8
  v_bfe_u32 v9, v6, 4, 1
  v_lshl_add_u32 v8, v9, 2, v8
  v_and_b32 v6, 3, v6
  v_add_u32 v6, v6, v8
  v_mul_u32_u24 v6, 1280, v6
  v_add_u32 v11, v6, v7
  v_add_u32 v5, 128, v1
  v_mul_u32_u24 v6, 6554, v5
  v_lshrrev_b32 v6, 16, v6
  v_mul_u32_u24 v7, 10, v6
  v_sub_u32 v7, v5, v7
  v_lshlrev_b32 v7, 4, v7
  v_bfe_u32 v8, v6, 2, 2
  v_lshlrev_b32 v8, 3, v8
  v_bfe_u32 v9, v6, 4, 1
  v_lshl_add_u32 v8, v9, 2, v8
  v_and_b32 v6, 3, v6
  v_add_u32 v6, v6, v8
  v_mul_u32_u24 v6, 1280, v6
  v_add_u32 v12, v6, v7
  v_add_u32 v5, 192, v1
  v_mul_u32_u24 v6, 6554, v5
  v_lshrrev_b32 v6, 16, v6
  v_mul_u32_u24 v7, 10, v6
  v_sub_u32 v7, v5, v7
  v_lshlrev_b32 v7, 4, v7
  v_bfe_u32 v8, v6, 2, 2
  v_lshlrev_b32 v8, 3, v8
  v_bfe_u32 v9, v6, 4, 1
  v_lshl_add_u32 v8, v9, 2, v8
  v_and_b32 v6, 3, v6
  v_add_u32 v6, v6, v8
  v_mul_u32_u24 v6, 1280, v6
  v_add_u32 v13, v6, v7
  v_add_u32 v5, 256, v1
  v_mul_u32_u24 v6, 6554, v5
  v_lshrrev_b32 v6, 16, v6
  v_mul_u32_u24 v7, 10, v6
  v_sub_u32 v7, v5, v7
  v_lshlrev_b32 v7, 4, v7
  v_bfe_u32 v8, v6, 2, 2
  v_lshlrev_b32 v8, 3, v8
  v_bfe_u32 v9, v6, 4, 1
  v_lshl_add_u32 v8, v9, 2, v8
  v_and_b32 v6, 3, v6
  v_add_u32 v6, v6, v8
  v_mul_u32_u24 v6, 1280, v6
  v_add_u32 v14, v6, v7
  v_lshlrev_b32 v15, 4, v1
  s_waitcnt lgkmcnt(0)
  s_add_u32 s56, s2, 0
  s_bitcmp1_b32 s56, 1
  s_cselect_b32 s52, s18, s12
  s_cselect_b32 s53, s19, s13
  s_mov_b32 s40, s52
  s_and_b32 s41, s53, 0xffff
  s_mov_b32 s42, 819200
  s_mov_b32 s43, 0x20000
  s_lshr_b32 s57, s56, 2
  s_mul_i32 s58, s57, 6554
  s_lshr_b32 s58, s58, 16
  s_mul_i32 s59, s58, 10
  s_sub_u32 s59, s57, s59
  s_lshl_b32 s59, s59, 1
  s_and_b32 s57, s56, 1
  s_add_u32 s59, s59, s57
  s_mul_i32 s59, s59, 40960
  s_mul_i32 s58, s58, 160
  s_add_u32 s59, s59, s58
  buffer_load_dwordx4 v[40:43], v10, s[40:43], s59 offen
  buffer_load_dwordx4 v[44:47], v11, s[40:43], s59 offen
  buffer_load_dwordx4 v[48:51], v12, s[40:43], s59 offen
  buffer_load_dwordx4 v[52:55], v13, s[40:43], s59 offen
  buffer_load_dwordx4 v[56:59], v14, s[40:43], s59 offen
  s_cmp_ge_u32 s2, 64
  s_cbranch_scc1 K2_RPLa
  s_add_u32 s56, s2, 256
  s_bitcmp1_b32 s56, 1
  s_cselect_b32 s52, s18, s12
  s_cselect_b32 s53, s19, s13
  s_mov_b32 s40, s52
  s_and_b32 s41, s53, 0xffff
  s_mov_b32 s42, 819200
  s_mov_b32 s43, 0x20000
  s_lshr_b32 s57, s56, 2
  s_mul_i32 s58, s57, 6554
  s_lshr_b32 s58, s58, 16
  s_mul_i32 s59, s58, 10
  s_sub_u32 s59, s57, s59
  s_lshl_b32 s59, s59, 1
  s_and_b32 s57, s56, 1
  s_add_u32 s59, s59, s57
  s_mul_i32 s59, s59, 40960
  s_mul_i32 s58, s58, 160
  s_add_u32 s59, s59, s58
  buffer_load_dwordx4 v[60:63], v10, s[40:43], s59 offen
  buffer_load_dwordx4 v[64:67], v11, s[40:43], s59 offen
  buffer_load_dwordx4 v[68:71], v12, s[40:43], s59 offen
  buffer_load_dwordx4 v[72:75], v13, s[40:43], s59 offen
  buffer_load_dwordx4 v[76:79], v14, s[40:43], s59 offen
K2_RPLa:
  s_waitcnt vmcnt(53)
  s_barrier
  s_waitcnt vmcnt(5)
  s_barrier
  s_branch K2_RPST
K2_BFILL:
  s_mov_b32 s60, 0
  s_mov_b32 s61, 122880
  s_mov_b32 s62, 0
K2_LD4:
  s_mov_b32 m0, s61
  s_add_u32 s61, s61, 1024
  buffer_load_dwordx4 v26, s[32:35], s60 offen lds
  s_add_u32 s60, s60, 1024
  s_mov_b32 m0, s61
  s_add_u32 s61, s61, 1024
  buffer_load_dwordx4 v26, s[32:35], s60 offen lds
  s_add_u32 s60, s60, 1024
  s_mov_b32 m0, s61
  s_add_u32 s61, s61, 1024
  buffer_load_dwordx4 v26, s[32:35], s60 offen lds
  s_add_u32 s60, s60, 1024
  s_mov_b32 m0, s61
  s_add_u32 s61, s61, 1024
  buffer_load_dwordx4 v26, s[32:35], s60 offen lds
  s_add_u32 s60, s60, 1024
  s_add_u32 s62, s62, 4
  s_cmp_lt_u32 s62, 24
  s_cbranch_scc1 K2_LD4
  v_mov_b32 v104, 0
  v_mov_b32 v105, 0
  v_mov_b32 v106, 0
  v_mov_b32 v107, 0
  v_add_u32 v112, 98304, v26
  ds_write_b128 v112, v[104:107] offset:0
  ds_write_b128 v112, v[104:107] offset:1024
  ds_write_b128 v112, v[104:107] offset:2048
  ds_write_b128 v112, v[104:107] offset:3072
  ds_write_b128 v112, v[104:107] offset:4096
  ds_write_b128 v112, v[104:107] offset:5120
  ds_write_b128 v112, v[104:107] offset:6144
  ds_write_b128 v112, v[104:107] offset:7168
  ds_write_b128 v112, v[104:107] offset:8192
  ds_write_b128 v112, v[104:107] offset:9216
  ds_write_b128 v112, v[104:107] offset:10240
  ds_write_b128 v112, v[104:107] offset:11264
  ds_write_b128 v112, v[104:107] offset:12288
  ds_write_b128 v112, v[104:107] offset:13312
  ds_write_b128 v112, v[104:107] offset:14336
  ds_write_b128 v112, v[104:107] offset:15360
  ds_write_b128 v112, v[104:107] offset:16384
  ds_write_b128 v112, v[104:107] offset:17408
  ds_write_b128 v112, v[104:107] offset:18432
  ds_write_b128 v112, v[104:107] offset:19456
  ds_write_b128 v112, v[104:107] offset:20480
  ds_write_b128 v112, v[104:107] offset:21504
  ds_write_b128 v112, v[104:107] offset:22528
  ds_write_b128 v112, v[104:107] offset:23552
  s_waitcnt lgkmcnt(0)
  v_and_b32 v2, 31, v1
  v_lshrrev_b32 v3, 5, v1
  v_mul_u32_u24 v113, 48, v2
  v_mul_u32_u24 v114, 3072, v3
  v_add_u32 v113, v113, v114
  v_add_u32 v113, 98304, v113
  v_mov_b32 v108, 0x3f800000
  ds_write_b32 v113, v108 offset:40
  ds_write_b32 v113, v108 offset:6184
  ds_write_b32 v113, v108 offset:12328
  ds_write_b32 v113, v108 offset:18472
  s_load_dwordx2 s[12:13], s[0:1], 32
  s_load_dwordx2 s[18:19], s[0:1], 56
  v_add_u32 v5, 0, v1
  v_mul_u32_u24 v6, 6554, v5
  v_lshrrev_b32 v6, 16, v6
  v_mul_u32_u24 v7, 10, v6
  v_sub_u32 v7, v5, v7
  v_lshlrev_b32 v7, 4, v7
  v_bfe_u32 v8, v6, 2, 2
  v_lshlrev_b32 v8, 3, v8
  v_bfe_u32 v9, v6, 4, 1
  v_lshl_add_u32 v8, v9, 2, v8
  v_and_b32 v6, 3, v6
  v_add_u32 v6, v6, v8
  v_mul_u32_u24 v6, 1280, v6
  v_add_u32 v10, v6, v7
  v_add_u32 v5, 64, v1
  v_mul_u32_u24 v6, 6554, v5
  v_lshrrev_b32 v6, 16, v6
  v_mul_u32_u24 v7, 10, v6
  v_sub_u32 v7, v5, v7
  v_lshlrev_b32 v7, 4, v7
  v_bfe_u32 v8, v6, 2, 2
  v_lshlrev_b32 v8, 3, v8
  v_bfe_u32 v9, v6, 4, 1
  v_lshl_add_u32 v8, v9, 2, v8
  v_and_b32 v6, 3, v6
  v_add_u32 v6, v6, v8
  v_mul_u32_u24 v6, 1280, v6
  v_add_u32 v11, v6, v7
  v_add_u32 v5, 128, v1
  v_mul_u32_u24 v6, 6554, v5
  v_lshrrev_b32 v6, 16, v6
  v_mul_u32_u24 v7, 10, v6
  v_sub_u32 v7, v5, v7
  v_lshlrev_b32 v7, 4, v7
  v_bfe_u32 v8, v6, 2, 2
  v_lshlrev_b32 v8, 3, v8
  v_bfe_u32 v9, v6, 4, 1
  v_lshl_add_u32 v8, v9, 2, v8
  v_and_b32 v6, 3, v6
  v_add_u32 v6, v6, v8
  v_mul_u32_u24 v6, 1280, v6
  v_add_u32 v12, v6, v7
  v_add_u32 v5, 192, v1
  v_mul_u32_u24 v6, 6554, v5
  v_lshrrev_b32 v6, 16, v6
  v_mul_u32_u24 v7, 10, v6
  v_sub_u32 v7, v5, v7
  v_lshlrev_b32 v7, 4, v7
  v_bfe_u32 v8, v6, 2, 2
  v_lshlrev_b32 v8, 3, v8
  v_bfe_u32 v9, v6, 4, 1
  v_lshl_add_u32 v8, v9, 2, v8
  v_and_b32 v6, 3, v6
  v_add_u32 v6, v6, v8
  v_mul_u32_u24 v6, 1280, v6
  v_add_u32 v13, v6, v7
  v_add_u32 v5, 256, v1
  v_mul_u32_u24 v6, 6554, v5
  v_lshrrev_b32 v6, 16, v6
  v_mul_u32_u24 v7, 10, v6
  v_sub_u32 v7, v5, v7
  v_lshlrev_b32 v7, 4, v7
  v_bfe_u32 v8, v6, 2, 2
  v_lshlrev_b32 v8, 3, v8
  v_bfe_u32 v9, v6, 4, 1
  v_lshl_add_u32 v8, v9, 2, v8
  v_and_b32 v6, 3, v6
  v_add_u32 v6, v6, v8
  v_mul_u32_u24 v6, 1280, v6
  v_add_u32 v14, v6, v7
  v_lshlrev_b32 v15, 4, v1
  s_waitcnt lgkmcnt(0)
  s_add_u32 s56, s2, 0
  s_bitcmp1_b32 s56, 1
  s_cselect_b32 s52, s18, s12
  s_cselect_b32 s53, s19, s13
  s_mov_b32 s40, s52
  s_and_b32 s41, s53, 0xffff
  s_mov_b32 s42, 819200
  s_mov_b32 s43, 0x20000
  s_lshr_b32 s57, s56, 2
  s_mul_i32 s58, s57, 6554
  s_lshr_b32 s58, s58, 16
  s_mul_i32 s59, s58, 10
  s_sub_u32 s59, s57, s59
  s_lshl_b32 s59, s59, 1
  s_and_b32 s57, s56, 1
  s_add_u32 s59, s59, s57
  s_mul_i32 s59, s59, 40960
  s_mul_i32 s58, s58, 160
  s_add_u32 s59, s59, s58
  buffer_load_dwordx4 v[40:43], v10, s[40:43], s59 offen
  buffer_load_dwordx4 v[44:47], v11, s[40:43], s59 offen
  buffer_load_dwordx4 v[48:51], v12, s[40:43], s59 offen
  buffer_load_dwordx4 v[52:55], v13, s[40:43], s59 offen
  buffer_load_dwordx4 v[56:59], v14, s[40:43], s59 offen
  s_cmp_ge_u32 s2, 64
  s_cbranch_scc1 K2_RPLb
  s_add_u32 s56, s2, 256
  s_bitcmp1_b32 s56, 1
  s_cselect_b32 s52, s18, s12
  s_cselect_b32 s53, s19, s13
  s_mov_b32 s40, s52
  s_and_b32 s41, s53, 0xffff
  s_mov_b32 s42, 819200
  s_mov_b32 s43, 0x20000
  s_lshr_b32 s57, s56, 2
  s_mul_i32 s58, s57, 6554
  s_lshr_b32 s58, s58, 16
  s_mul_i32 s59, s58, 10
  s_sub_u32 s59, s57, s59
  s_lshl_b32 s59, s59, 1
  s_and_b32 s57, s56, 1
  s_add_u32 s59, s59, s57
  s_mul_i32 s59, s59, 40960
  s_mul_i32 s58, s58, 160
  s_add_u32 s59, s59, s58
  buffer_load_dwordx4 v[60:63], v10, s[40:43], s59 offen
  buffer_load_dwordx4 v[64:67], v11, s[40:43], s59 offen
  buffer_load_dwordx4 v[68:71], v12, s[40:43], s59 offen
  buffer_load_dwordx4 v[72:75], v13, s[40:43], s59 offen
  buffer_load_dwordx4 v[76:79], v14, s[40:43], s59 offen
K2_RPLb:
  s_waitcnt vmcnt(29) lgkmcnt(0)
  s_barrier
  s_waitcnt vmcnt(5)
  s_barrier
K2_RPST:
  s_setprio 0
  s_waitcnt vmcnt(0)
  s_add_u32 s36, s26, 17104896
  s_addc_u32 s37, s27, 0
  s_and_b32 s37, s37, 0xffff
  s_mov_b32 s38, 1638400
  s_mov_b32 s39, 0x20000
  s_add_u32 s60, s2, 0
  s_mul_i32 s60, s60, 5120
  s_add_u32 s61, s60, 4096
  buffer_store_dwordx4 v[40:43], v15, s[36:39], s60 offen offset:0 sc1
  buffer_store_dwordx4 v[44:47], v15, s[36:39], s60 offen offset:1024 sc1
  buffer_store_dwordx4 v[48:51], v15, s[36:39], s60 offen offset:2048 sc1
  buffer_store_dwordx4 v[52:55], v15, s[36:39], s60 offen offset:3072 sc1
  buffer_store_dwordx4 v[56:59], v15, s[36:39], s61 offen sc1
  s_cmp_ge_u32 s2, 64
  s_cbranch_scc1 K2_RPE
  s_add_u32 s60, s2, 256
  s_mul_i32 s60, s60, 5120
  s_add_u32 s61, s60, 4096
  buffer_store_dwordx4 v[60:63], v15, s[36:39], s60 offen offset:0 sc1
  buffer_store_dwordx4 v[64:67], v15, s[36:39], s60 offen offset:1024 sc1
  buffer_store_dwordx4 v[68:71], v15, s[36:39], s60 offen offset:2048 sc1
  buffer_store_dwordx4 v[72:75], v15, s[36:39], s60 offen offset:3072 sc1
  buffer_store_dwordx4 v[76:79], v15, s[36:39], s61 offen sc1
K2_RPE:
  s_endpgm
K2_SLOWA:
  s_mov_b32 s68, 0
  s_mov_b32 s69, 64
  s_waitcnt vmcnt(0) lgkmcnt(0)
  s_nop 7
  s_nop 7
  v_mov_b32 v10, 0
  v_mov_b32 v166, 0xff7fffff
  s_mov_b32 s66, 0
K2_SA_L1:
  s_add_u32 s67, s68, s66
  s_mul_i32 s67, s67, 3072
  buffer_load_dwordx4 v[28:31], v20, s[28:31], s67 offen
  buffer_load_dwordx4 v[32:35], v21, s[28:31], s67 offen
  v_mov_b32 v80, 0
  v_mov_b32 v81, 0
  v_mov_b32 v82, 0
  v_mov_b32 v83, 0
  v_mov_b32 v84, 0
  v_mov_b32 v85, 0
  v_mov_b32 v86, 0
  v_mov_b32 v87, 0
  v_mov_b32 v88, 0
  v_mov_b32 v89, 0
  v_mov_b32 v90, 0
  v_mov_b32 v91, 0
  v_mov_b32 v92, 0
  v_mov_b32 v93, 0
  v_mov_b32 v94, 0
  v_mov_b32 v95, 0
  s_waitcnt vmcnt(0)
  s_nop 1
  v_mfma_f32_32x32x16_bf16 v[64:79], v[28:31], v[4:7], v[80:95]
  v_mfma_f32_32x32x16_bf16 v[64:79], v[32:35], v[8:11], v[64:79]
  s_nop 7
  s_nop 7
  v_max_f32 v166, v166, v64
  v_max_f32 v166, v166, v65
  v_max_f32 v166, v166, v66
  v_max_f32 v166, v166, v67
  v_max_f32 v166, v166, v68
  v_max_f32 v166, v166, v69
  v_max_f32 v166, v166, v70
  v_max_f32 v166, v166, v71
  v_max_f32 v166, v166, v72
  v_max_f32 v166, v166, v73
  v_max_f32 v166, v166, v74
  v_max_f32 v166, v166, v75
  v_max_f32 v166, v166, v76
  v_max_f32 v166, v166, v77
  v_max_f32 v166, v166, v78
  v_max_f32 v166, v166, v79
  s_add_u32 s66, s66, 1
  s_cmp_lt_u32 s66, s69
  s_cbranch_scc1 K2_SA_L1
  v_mov_b32 v152, v166
  v_mov_b32 v153, v166
  s_nop 1
  v_permlane32_swap_b32 v152, v153
  s_nop 1
  v_max_f32 v152, v152, v153
  s_nop 0
  v_sub_f32 v152, 0, v152
  v_mov_b32 v153, 0
  v_cvt_pk_bf16_f32 v152, v152, v153
  s_mov_b64 exec, 0xffffffff
  v_mov_b32 v10, v152
  s_mov_b64 exec, -1
  s_nop 1
  v_mov_b32 v104, 0
  v_mov_b32 v105, 0
  v_mov_b32 v106, 0
  v_mov_b32 v107, 0
  v_mov_b32 v108, 0
  v_mov_b32 v109, 0
  v_mov_b32 v110, 0
  v_mov_b32 v111, 0
  v_mov_b32 v112, 0
  v_mov_b32 v113, 0
  v_mov_b32 v114, 0
  v_mov_b32 v115, 0
  v_mov_b32 v116, 0
  v_mov_b32 v117, 0
  v_mov_b32 v118, 0
  v_mov_b32 v119, 0
  s_mov_b32 s66, 0
K2_SA_L2:
  s_add_u32 s67, s68, s66
  s_mul_i32 s67, s67, 3072
  buffer_load_dwordx4 v[28:31], v20, s[28:31], s67 offen
  buffer_load_dwordx4 v[32:35], v21, s[28:31], s67 offen
  buffer_load_dwordx4 v[44:47], v22, s[28:31], s67 offen
  buffer_load_dwordx4 v[48:51], v22, s[28:31], s67 offen offset:768
  v_mov_b32 v80, 0
  v_mov_b32 v81, 0
  v_mov_b32 v82, 0
  v_mov_b32 v83, 0
  v_mov_b32 v84, 0
  v_mov_b32 v85, 0
  v_mov_b32 v86, 0
  v_mov_b32 v87, 0
  v_mov_b32 v88, 0
  v_mov_b32 v89, 0
  v_mov_b32 v90, 0
  v_mov_b32 v91, 0
  v_mov_b32 v92, 0
  v_mov_b32 v93, 0
  v_mov_b32 v94, 0
  v_mov_b32 v95, 0
  s_waitcnt vmcnt(0)
  s_nop 1
  v_mfma_f32_32x32x16_bf16 v[64:79], v[28:31], v[4:7], v[80:95]
  v_mfma_f32_32x32x16_bf16 v[64:79], v[32:35], v[8:11], v[64:79]
  s_nop 7
  s_nop 7
  v_exp_f32 v64, v64
  v_exp_f32 v65, v65
  v_exp_f32 v66, v66
  v_exp_f32 v67, v67
  v_exp_f32 v68, v68
  v_exp_f32 v69, v69
  v_exp_f32 v70, v70
  v_exp_f32 v71, v71
  v_exp_f32 v72, v72
  v_exp_f32 v73, v73
  v_exp_f32 v74, v74
  v_exp_f32 v75, v75
  v_exp_f32 v76, v76
  v_exp_f32 v77, v77
  v_exp_f32 v78, v78
  v_exp_f32 v79, v79
  s_nop 0
  v_cvt_pk_bf16_f32 v96, v64, v65
  v_cvt_pk_bf16_f32 v97, v66, v67
  v_cvt_pk_bf16_f32 v98, v68, v69
  v_cvt_pk_bf16_f32 v99, v70, v71
  v_cvt_pk_bf16_f32 v100, v72, v73
  v_cvt_pk_bf16_f32 v101, v74, v75
  v_cvt_pk_bf16_f32 v102, v76, v77
  v_cvt_pk_bf16_f32 v103, v78, v79
  s_nop 1
  v_mfma_f32_32x32x16_bf16 v[104:119], v[44:47], v[96:99], v[104:119]
  v_mfma_f32_32x32x16_bf16 v[104:119], v[48:51], v[100:103], v[104:119]
  s_add_u32 s66, s66, 1
  s_cmp_lt_u32 s66, s69
  s_cbranch_scc1 K2_SA_L2
  s_nop 7
  s_nop 7
  v_mov_b32 v152, v112
  v_mov_b32 v153, v112
  s_nop 1
  v_permlane32_swap_b32 v152, v153
  s_nop 1
  v_rcp_f32 v153, v153
  s_nop 0
  v_pk_mul_f32 v[104:105], v[104:105], v[152:153] op_sel:[0,1] op_sel_hi:[1,1]
  v_pk_mul_f32 v[106:107], v[106:107], v[152:153] op_sel:[0,1] op_sel_hi:[1,1]
  v_pk_mul_f32 v[108:109], v[108:109], v[152:153] op_sel:[0,1] op_sel_hi:[1,1]
  v_pk_mul_f32 v[110:111], v[110:111], v[152:153] op_sel:[0,1] op_sel_hi:[1,1]
  v_pk_mul_f32 v[112:113], v[112:113], v[152:153] op_sel:[0,1] op_sel_hi:[1,1]
  v_pk_mul_f32 v[114:115], v[114:115], v[152:153] op_sel:[0,1] op_sel_hi:[1,1]
  v_cvt_pk_bf16_f32 v156, v104, v105
  v_cvt_pk_bf16_f32 v157, v106, v107
  v_cvt_pk_bf16_f32 v158, v108, v109
  v_cvt_pk_bf16_f32 v159, v110, v111
  v_cvt_pk_bf16_f32 v160, v112, v113
  v_cvt_pk_bf16_f32 v161, v114, v115
  v_add_u32 v154, s52, v2
  v_mul_u32_u24 v154, 2560, v154
  s_mul_i32 s60, s50, 40
  s_add_u32 s60, s60, 0
  v_lshl_add_u32 v155, v3, 4, v154
  v_permlane32_swap_b32 v156, v158
  v_permlane32_swap_b32 v157, v159
  s_nop 1
  buffer_store_dwordx4 v[156:159], v155, s[40:43], s60 offen
  s_mov_b64 exec, 0xffffffff
  buffer_store_dwordx2 v[160:161], v154, s[40:43], s60 offen offset:32
  s_mov_b64 exec, -1
  s_mul_i32 s59, s48, 3072
  s_add_u32 s59, s59, 98304
  v_add_u32 v23, s59, v20
  v_add_u32 v24, s59, v21
  v_add_u32 v25, s59, v22
  s_waitcnt vmcnt(0) lgkmcnt(0)
  ds_read_b128 v[28:31], v23 offset:24576
  ds_read_b128 v[32:35], v24 offset:24576
  s_waitcnt lgkmcnt(0)
  v_mfma_f32_32x32x16_bf16 v[64:79], v[28:31], v[12:15], v[120:135]
  v_mfma_f32_32x32x16_bf16 v[64:79], v[32:35], v[16:19], v[64:79]
  ds_read_b128 v[36:39], v23 offset:0
  ds_read_b128 v[40:43], v24 offset:0
  ds_read_b128 v[44:47], v25 offset:24576
  ds_read_b128 v[48:51], v25 offset:25344
  s_nop 7
  s_nop 7
  s_branch K2_BMAX
K2_SLOWB:
  s_lshr_b32 s70, s52, 5
  s_min_u32 s69, s70, 8
  s_sub_u32 s68, s70, s69
  s_add_u32 s69, s69, 1
  s_waitcnt vmcnt(0) lgkmcnt(0)
  s_nop 7
  s_nop 7
  v_mov_b32 v18, 0
  v_mov_b32 v166, 0xff7fffff
  s_mov_b32 s66, 0
K2_SB_L1:
  s_add_u32 s67, s68, s66
  s_mul_i32 s67, s67, 3072
  buffer_load_dwordx4 v[28:31], v20, s[32:35], s67 offen
  buffer_load_dwordx4 v[32:35], v21, s[32:35], s67 offen
  v_mov_b32 v80, 0
  v_mov_b32 v81, 0
  v_mov_b32 v82, 0
  v_mov_b32 v83, 0
  v_mov_b32 v84, 0
  v_mov_b32 v85, 0
  v_mov_b32 v86, 0
  v_mov_b32 v87, 0
  v_mov_b32 v88, 0
  v_mov_b32 v89, 0
  v_mov_b32 v90, 0
  v_mov_b32 v91, 0
  v_mov_b32 v92, 0
  v_mov_b32 v93, 0
  v_mov_b32 v94, 0
  v_mov_b32 v95, 0
  s_sub_u32 s67, s69, 1
  s_cmp_lg_u32 s66, s67
  s_cbranch_scc1 K2_SB_c1_a
  v_mov_b32 v80, v120
  v_mov_b32 v81, v121
  v_mov_b32 v82, v122
  v_mov_b32 v83, v123
  v_mov_b32 v84, v124
  v_mov_b32 v85, v125
  v_mov_b32 v86, v126
  v_mov_b32 v87, v127
  v_mov_b32 v88, v128
  v_mov_b32 v89, v129
  v_mov_b32 v90, v130
  v_mov_b32 v91, v131
  v_mov_b32 v92, v132
  v_mov_b32 v93, v133
  v_mov_b32 v94, v134
  v_mov_b32 v95, v135
  s_branch K2_SB_c1_b
K2_SB_c1_a:
  s_cmp_lg_u32 s66, 0
  s_cbranch_scc1 K2_SB_c1_b
  s_cmp_lg_u32 s69, 9
  s_cbranch_scc1 K2_SB_c1_b
  v_mov_b32 v80, v136
  v_mov_b32 v81, v137
  v_mov_b32 v82, v138
  v_mov_b32 v83, v139
  v_mov_b32 v84, v140
  v_mov_b32 v85, v141
  v_mov_b32 v86, v142
  v_mov_b32 v87, v143
  v_mov_b32 v88, v144
  v_mov_b32 v89, v145
  v_mov_b32 v90, v146
  v_mov_b32 v91, v147
  v_mov_b32 v92, v148
  v_mov_b32 v93, v149
  v_mov_b32 v94, v150
  v_mov_b32 v95, v151
K2_SB_c1_b:
  s_waitcnt vmcnt(0)
  s_nop 1
  v_mfma_f32_32x32x16_bf16 v[64:79], v[28:31], v[12:15], v[80:95]
  v_mfma_f32_32x32x16_bf16 v[64:79], v[32:35], v[16:19], v[64:79]
  s_nop 7
  s_nop 7
  v_max_f32 v166, v166, v64
  v_max_f32 v166, v166, v65
  v_max_f32 v166, v166, v66
  v_max_f32 v166, v166, v67
  v_max_f32 v166, v166, v68
  v_max_f32 v166, v166, v69
  v_max_f32 v166, v166, v70
  v_max_f32 v166, v166, v71
  v_max_f32 v166, v166, v72
  v_max_f32 v166, v166, v73
  v_max_f32 v166, v166, v74
  v_max_f32 v166, v166, v75
  v_max_f32 v166, v166, v76
  v_max_f32 v166, v166, v77
  v_max_f32 v166, v166, v78
  v_max_f32 v166, v166, v79
  s_add_u32 s66, s66, 1
  s_cmp_lt_u32 s66, s69
  s_cbranch_scc1 K2_SB_L1
  v_mov_b32 v152, v166
  v_mov_b32 v153, v166
  s_nop 1
  v_permlane32_swap_b32 v152, v153
  s_nop 1
  v_max_f32 v152, v152, v153
  s_nop 0
  v_sub_f32 v152, 0, v152
  v_mov_b32 v153, 0
  v_cvt_pk_bf16_f32 v152, v152, v153
  s_mov_b64 exec, 0xffffffff
  v_mov_b32 v18, v152
  s_mov_b64 exec, -1
  s_nop 1
  v_mov_b32 v104, 0
  v_mov_b32 v105, 0
  v_mov_b32 v106, 0
  v_mov_b32 v107, 0
  v_mov_b32 v108, 0
  v_mov_b32 v109, 0
  v_mov_b32 v110, 0
  v_mov_b32 v111, 0
  v_mov_b32 v112, 0
  v_mov_b32 v113, 0
  v_mov_b32 v114, 0
  v_mov_b32 v115, 0
  v_mov_b32 v116, 0
  v_mov_b32 v117, 0
  v_mov_b32 v118, 0
  v_mov_b32 v119, 0
  s_mov_b32 s66, 0
K2_SB_L2:
  s_add_u32 s67, s68, s66
  s_mul_i32 s67, s67, 3072
  buffer_load_dwordx4 v[28:31], v20, s[32:35], s67 offen
  buffer_load_dwordx4 v[32:35], v21, s[32:35], s67 offen
  buffer_load_dwordx4 v[44:47], v22, s[32:35], s67 offen
  buffer_load_dwordx4 v[48:51], v22, s[32:35], s67 offen offset:768
  v_mov_b32 v80, 0
  v_mov_b32 v81, 0
  v_mov_b32 v82, 0
  v_mov_b32 v83, 0
  v_mov_b32 v84, 0
  v_mov_b32 v85, 0
  v_mov_b32 v86, 0
  v_mov_b32 v87, 0
  v_mov_b32 v88, 0
  v_mov_b32 v89, 0
  v_mov_b32 v90, 0
  v_mov_b32 v91, 0
  v_mov_b32 v92, 0
  v_mov_b32 v93, 0
  v_mov_b32 v94, 0
  v_mov_b32 v95, 0
  s_sub_u32 s67, s69, 1
  s_cmp_lg_u32 s66, s67
  s_cbranch_scc1 K2_SB_c2_a
  v_mov_b32 v80, v120
  v_mov_b32 v81, v121
  v_mov_b32 v82, v122
  v_mov_b32 v83, v123
  v_mov_b32 v84, v124
  v_mov_b32 v85, v125
  v_mov_b32 v86, v126
  v_mov_b32 v87, v127
  v_mov_b32 v88, v128
  v_mov_b32 v89, v129
  v_mov_b32 v90, v130
  v_mov_b32 v91, v131
  v_mov_b32 v92, v132
  v_mov_b32 v93, v133
  v_mov_b32 v94, v134
  v_mov_b32 v95, v135
  s_branch K2_SB_c2_b
K2_SB_c2_a:
  s_cmp_lg_u32 s66, 0
  s_cbranch_scc1 K2_SB_c2_b
  s_cmp_lg_u32 s69, 9
  s_cbranch_scc1 K2_SB_c2_b
  v_mov_b32 v80, v136
  v_mov_b32 v81, v137
  v_mov_b32 v82, v138
  v_mov_b32 v83, v139
  v_mov_b32 v84, v140
  v_mov_b32 v85, v141
  v_mov_b32 v86, v142
  v_mov_b32 v87, v143
  v_mov_b32 v88, v144
  v_mov_b32 v89, v145
  v_mov_b32 v90, v146
  v_mov_b32 v91, v147
  v_mov_b32 v92, v148
  v_mov_b32 v93, v149
  v_mov_b32 v94, v150
  v_mov_b32 v95, v151
K2_SB_c2_b:
  s_waitcnt vmcnt(0)
  s_nop 1
  v_mfma_f32_32x32x16_bf16 v[64:79], v[28:31], v[12:15], v[80:95]
  v_mfma_f32_32x32x16_bf16 v[64:79], v[32:35], v[16:19], v[64:79]
  s_nop 7
  s_nop 7
  v_exp_f32 v64, v64
  v_exp_f32 v65, v65
  v_exp_f32 v66, v66
  v_exp_f32 v67, v67
  v_exp_f32 v68, v68
  v_exp_f32 v69, v69
  v_exp_f32 v70, v70
  v_exp_f32 v71, v71
  v_exp_f32 v72, v72
  v_exp_f32 v73, v73
  v_exp_f32 v74, v74
  v_exp_f32 v75, v75
  v_exp_f32 v76, v76
  v_exp_f32 v77, v77
  v_exp_f32 v78, v78
  v_exp_f32 v79, v79
  s_nop 0
  v_cvt_pk_bf16_f32 v96, v64, v65
  v_cvt_pk_bf16_f32 v97, v66, v67
  v_cvt_pk_bf16_f32 v98, v68, v69
  v_cvt_pk_bf16_f32 v99, v70, v71
  v_cvt_pk_bf16_f32 v100, v72, v73
  v_cvt_pk_bf16_f32 v101, v74, v75
  v_cvt_pk_bf16_f32 v102, v76, v77
  v_cvt_pk_bf16_f32 v103, v78, v79
  s_nop 1
  v_mfma_f32_32x32x16_bf16 v[104:119], v[44:47], v[96:99], v[104:119]
  v_mfma_f32_32x32x16_bf16 v[104:119], v[48:51], v[100:103], v[104:119]
  s_add_u32 s66, s66, 1
  s_cmp_lt_u32 s66, s69
  s_cbranch_scc1 K2_SB_L2
  s_nop 7
  s_nop 7
  v_mov_b32 v152, v112
  v_mov_b32 v153, v112
  s_nop 1
  v_permlane32_swap_b32 v152, v153
  s_nop 1
  v_rcp_f32 v153, v153
  s_nop 0
  v_pk_mul_f32 v[104:105], v[104:105], v[152:153] op_sel:[0,1] op_sel_hi:[1,1]
  v_pk_mul_f32 v[106:107], v[106:107], v[152:153] op_sel:[0,1] op_sel_hi:[1,1]
  v_pk_mul_f32 v[108:109], v[108:109], v[152:153] op_sel:[0,1] op_sel_hi:[1,1]
  v_pk_mul_f32 v[110:111], v[110:111], v[152:153] op_sel:[0,1] op_sel_hi:[1,1]
  v_pk_mul_f32 v[112:113], v[112:113], v[152:153] op_sel:[0,1] op_sel_hi:[1,1]
  v_pk_mul_f32 v[114:115], v[114:115], v[152:153] op_sel:[0,1] op_sel_hi:[1,1]
  v_cvt_pk_bf16_f32 v156, v104, v105
  v_cvt_pk_bf16_f32 v157, v106, v107
  v_cvt_pk_bf16_f32 v158, v108, v109
  v_cvt_pk_bf16_f32 v159, v110, v111
  v_cvt_pk_bf16_f32 v160, v112, v113
  v_cvt_pk_bf16_f32 v161, v114, v115
  v_add_u32 v154, s52, v2
  v_mul_u32_u24 v154, 2560, v154
  s_mul_i32 s60, s50, 40
  s_add_u32 s60, s60, 1280
  v_lshl_add_u32 v155, v3, 4, v154
  v_permlane32_swap_b32 v156, v158
  v_permlane32_swap_b32 v157, v159
  s_nop 1
  buffer_store_dwordx4 v[156:159], v155, s[40:43], s60 offen
  s_mov_b64 exec, 0xffffffff
  buffer_store_dwordx2 v[160:161], v154, s[40:43], s60 offen offset:32
  s_mov_b64 exec, -1
K2_END:
  s_endpgm
  .globl k3_kernel
  .p2align 8
  .type k3_kernel,@function
k3_kernel:
  s_cmp_ge_u32 s2, 256
  s_cbranch_scc1 K3_END
  s_load_dwordx8 s[4:11], s[0:1], 0
  s_load_dwordx8 s[12:19], s[0:1], 32
  s_load_dwordx4 s[20:23], s[0:1], 64
  s_load_dwordx4 s[24:27], s[0:1], 80
  v_lshrrev_b32 v2, 6, v0
  v_and_b32 v1, 63, v0
  s_and_b32 s49, s2, 7
  s_lshr_b32 s50, s2, 3
  v_readfirstlane_b32 s48, v2
  s_and_b32 s51, s50, 3
  s_lshl_b32 s49, s49, 8
  s_lshl_b32 s51, s51, 6
  s_add_u32 s49, s49, s51
  s_lshr_b32 s50, s50, 2
  s_cmp_ge_u32 s48, 4
  s_cbranch_scc1 K3_LOADER
  s_lshr_b32 s60, s48, 1
  s_and_b32 s61, s48, 1
  v_and_b32 v2, 15, v1
  v_lshrrev_b32 v3, 4, v1
  v_lshrrev_b32 v4, 2, v2
  v_and_b32 v5, 3, v1
  s_lshl_b32 s62, s61, 5
  s_lshl_b32 s63, s60, 4
  s_add_u32 s62, s62, s63
  s_add_u32 s62, s62, s49
  v_add_u32 v20, s62, v2
  v_lshlrev_b32 v21, 2, v20
  s_waitcnt lgkmcnt(0)
  s_add_u32 s40, s26, 11796480
  s_addc_u32 s41, s27, 0
  s_and_b32 s41, s41, 0xffff
  s_mov_b32 s42, 8192
  s_mov_b32 s43, 0x20000
  s_mov_b32 s44, s22
  s_and_b32 s45, s23, 0xffff
  s_mov_b32 s46, 2621440
  s_mov_b32 s47, 0x20000
  buffer_load_dword v22, v21, s[40:43], 0 offen
  s_lshl_b32 s62, s60, 13
  s_lshl_b32 s63, s61, 12
  s_add_u32 s62, s62, s63
  v_lshlrev_b32 v6, 7, v2
  v_add_u32 v6, s62, v6
  v_and_b32 v17, 7, v2
  v_xor_b32 v17, v17, v3
  v_lshlrev_b32 v17, 4, v17
  v_add_u32 v6, v6, v17
  v_xor_b32 v7, 64, v6
  v_lshl_add_u32 v17, v3, 2, v4
  v_mul_u32_u24 v18, 160, v17
  v_lshl_add_u32 v18, v5, 3, v18
  s_mul_i32 s62, s60, 10240
  s_add_u32 s62, s62, 16384
  v_add_u32 v8, s62, v18
  v_mul_u32_u24 v23, 1280, v20
  v_lshl_add_u32 v23, v3, 3, v23
  s_mul_i32 s68, s50, 160
  v_mul_u32_u24 v9, 1280, v20
  v_and_b32 v10, 1, v3
  v_lshl_add_u32 v9, v10, 5, v9
  v_lshrrev_b32 v10, 1, v3
  v_lshl_add_u32 v9, v10, 4, v9
  v_mov_b32 v24, 0
  v_mov_b32 v25, 0
  v_mov_b32 v26, 0
  v_mov_b32 v27, 0
  v_mov_b32 v28, 0
  v_mov_b32 v29, 0
  v_mov_b32 v30, 0
  v_mov_b32 v31, 0
  v_mov_b32 v32, 0
  v_mov_b32 v33, 0
  v_mov_b32 v34, 0
  v_mov_b32 v35, 0
  v_mov_b32 v36, 0
  v_mov_b32 v37, 0
  v_mov_b32 v38, 0
  v_mov_b32 v39, 0
  v_mov_b32 v40, 0
  v_mov_b32 v41, 0
  v_mov_b32 v42, 0
  v_mov_b32 v43, 0
  v_mov_b32 v44, 0
  v_mov_b32 v45, 0
  v_mov_b32 v46, 0
  v_mov_b32 v47, 0
  v_mov_b32 v48, 0
  v_mov_b32 v49, 0
  v_mov_b32 v50, 0
  v_mov_b32 v51, 0
  v_mov_b32 v52, 0
  v_mov_b32 v53, 0
  v_mov_b32 v54, 0
  v_mov_b32 v55, 0
  v_mov_b32 v56, 0
  v_mov_b32 v57, 0
  v_mov_b32 v58, 0
  v_mov_b32 v59, 0
  v_mov_b32 v60, 0
  v_mov_b32 v61, 0
  v_mov_b32 v62, 0
  v_mov_b32 v63, 0
  s_mov_b32 s66, 0
  s_mov_b32 s67, 1
  s_barrier
  v_add_u32 v12, s66, v6
  v_add_u32 v13, s66, v7
  v_add_u32 v14, s66, v8
  ds_read_b128 v[64:67], v12
  ds_read_b64_tr_b16 v[80:81], v14 offset:0
  ds_read_b64_tr_b16 v[82:83], v14 offset:2560
  ds_read_b128 v[68:71], v12 offset:2048
  ds_read_b64_tr_b16 v[84:85], v14 offset:32
  ds_read_b64_tr_b16 v[86:87], v14 offset:2592
  ds_read_b64_tr_b16 v[88:89], v14 offset:64
  ds_read_b64_tr_b16 v[90:91], v14 offset:2624
  ds_read_b64_tr_b16 v[92:93], v14 offset:96
  ds_read_b64_tr_b16 v[94:95], v14 offset:2656
  ds_read_b64_tr_b16 v[96:97], v14 offset:128
  ds_read_b64_tr_b16 v[98:99], v14 offset:2688
  s_waitcnt lgkmcnt(0)
  v_mfma_f32_16x16x32_bf16 v[24:27], v[80:83], v[64:67], v[24:27]
  ds_read_b128 v[72:75], v13
  ds_read_b64_tr_b16 v[100:101], v14 offset:5120
  v_mfma_f32_16x16x32_bf16 v[28:31], v[80:83], v[68:71], v[28:31]
  ds_read_b64_tr_b16 v[102:103], v14 offset:7680
  ds_read_b128 v[76:79], v13 offset:2048
  v_mfma_f32_16x16x32_bf16 v[32:35], v[84:87], v[64:67], v[32:35]
  ds_read_b64_tr_b16 v[104:105], v14 offset:5152
  ds_read_b64_tr_b16 v[106:107], v14 offset:7712
  v_mfma_f32_16x16x32_bf16 v[36:39], v[84:87], v[68:71], v[36:39]
  ds_read_b64_tr_b16 v[108:109], v14 offset:5184
  ds_read_b64_tr_b16 v[110:111], v14 offset:7744
  v_mfma_f32_16x16x32_bf16 v[40:43], v[88:91], v[64:67], v[40:43]
  ds_read_b64_tr_b16 v[112:113], v14 offset:5216
  ds_read_b64_tr_b16 v[114:115], v14 offset:7776
  v_mfma_f32_16x16x32_bf16 v[44:47], v[88:91], v[68:71], v[44:47]
  ds_read_b64_tr_b16 v[116:117], v14 offset:5248
  ds_read_b64_tr_b16 v[118:119], v14 offset:7808
  v_mfma_f32_16x16x32_bf16 v[48:51], v[92:95], v[64:67], v[48:51]
  v_mfma_f32_16x16x32_bf16 v[52:55], v[92:95], v[68:71], v[52:55]
  v_mfma_f32_16x16x32_bf16 v[56:59], v[96:99], v[64:67], v[56:59]
  v_mfma_f32_16x16x32_bf16 v[60:63], v[96:99], v[68:71], v[60:63]
  s_waitcnt lgkmcnt(0)
K3_LP:
  s_add_u32 s66, s66, 36864
  s_cmp_eq_u32 s66, 147456
  s_cselect_b32 s66, 0, s66
  s_barrier
  v_add_u32 v12, s66, v6
  v_add_u32 v13, s66, v7
  v_add_u32 v14, s66, v8
  v_mfma_f32_16x16x32_bf16 v[24:27], v[100:103], v[72:75], v[24:27]
  ds_read_b128 v[64:67], v12
  ds_read_b64_tr_b16 v[80:81], v14 offset:0
  v_mfma_f32_16x16x32_bf16 v[28:31], v[100:103], v[76:79], v[28:31]
  ds_read_b64_tr_b16 v[82:83], v14 offset:2560
  ds_read_b128 v[68:71], v12 offset:2048
  v_mfma_f32_16x16x32_bf16 v[32:35], v[104:107], v[72:75], v[32:35]
  ds_read_b64_tr_b16 v[84:85], v14 offset:32
  ds_read_b64_tr_b16 v[86:87], v14 offset:2592
  v_mfma_f32_16x16x32_bf16 v[36:39], v[104:107], v[76:79], v[36:39]
  ds_read_b64_tr_b16 v[88:89], v14 offset:64
  ds_read_b64_tr_b16 v[90:91], v14 offset:2624
  v_mfma_f32_16x16x32_bf16 v[40:43], v[108:111], v[72:75], v[40:43]
  ds_read_b64_tr_b16 v[92:93], v14 offset:96
  ds_read_b64_tr_b16 v[94:95], v14 offset:2656
  v_mfma_f32_16x16x32_bf16 v[44:47], v[108:111], v[76:79], v[44:47]
  ds_read_b64_tr_b16 v[96:97], v14 offset:128
  ds_read_b64_tr_b16 v[98:99], v14 offset:2688
  v_mfma_f32_16x16x32_bf16 v[48:51], v[112:115], v[72:75], v[48:51]
  v_mfma_f32_16x16x32_bf16 v[52:55], v[112:115], v[76:79], v[52:55]
  v_mfma_f32_16x16x32_bf16 v[56:59], v[116:119], v[72:75], v[56:59]
  v_mfma_f32_16x16x32_bf16 v[60:63], v[116:119], v[76:79], v[60:63]
  s_waitcnt lgkmcnt(0)
  v_mfma_f32_16x16x32_bf16 v[24:27], v[80:83], v[64:67], v[24:27]
  ds_read_b128 v[72:75], v13
  ds_read_b64_tr_b16 v[100:101], v14 offset:5120
  v_mfma_f32_16x16x32_bf16 v[28:31], v[80:83], v[68:71], v[28:31]
  ds_read_b64_tr_b16 v[102:103], v14 offset:7680
  ds_read_b128 v[76:79], v13 offset:2048
  v_mfma_f32_16x16x32_bf16 v[32:35], v[84:87], v[64:67], v[32:35]
  ds_read_b64_tr_b16 v[104:105], v14 offset:5152
  ds_read_b64_tr_b16 v[106:107], v14 offset:7712
  v_mfma_f32_16x16x32_bf16 v[36:39], v[84:87], v[68:71], v[36:39]
  ds_read_b64_tr_b16 v[108:109], v14 offset:5184
  ds_read_b64_tr_b16 v[110:111], v14 offset:7744
  v_mfma_f32_16x16x32_bf16 v[40:43], v[88:91], v[64:67], v[40:43]
  ds_read_b64_tr_b16 v[112:113], v14 offset:5216
  ds_read_b64_tr_b16 v[114:115], v14 offset:7776
  v_mfma_f32_16x16x32_bf16 v[44:47], v[88:91], v[68:71], v[44:47]
  ds_read_b64_tr_b16 v[116:117], v14 offset:5248
  ds_read_b64_tr_b16 v[118:119], v14 offset:7808
  v_mfma_f32_16x16x32_bf16 v[48:51], v[92:95], v[64:67], v[48:51]
  v_mfma_f32_16x16x32_bf16 v[52:55], v[92:95], v[68:71], v[52:55]
  v_mfma_f32_16x16x32_bf16 v[56:59], v[96:99], v[64:67], v[56:59]
  v_mfma_f32_16x16x32_bf16 v[60:63], v[96:99], v[68:71], v[60:63]
  s_waitcnt lgkmcnt(0)
  s_add_u32 s67, s67, 1
  s_cmp_lt_u32 s67, 10
  s_cbranch_scc1 K3_LP
  v_mfma_f32_16x16x32_bf16 v[24:27], v[100:103], v[72:75], v[24:27]
  v_mfma_f32_16x16x32_bf16 v[28:31], v[100:103], v[76:79], v[28:31]
  v_mfma_f32_16x16x32_bf16 v[32:35], v[104:107], v[72:75], v[32:35]
  v_mfma_f32_16x16x32_bf16 v[36:39], v[104:107], v[76:79], v[36:39]
  v_mfma_f32_16x16x32_bf16 v[40:43], v[108:111], v[72:75], v[40:43]
  v_mfma_f32_16x16x32_bf16 v[44:47], v[108:111], v[76:79], v[44:47]
  v_mfma_f32_16x16x32_bf16 v[48:51], v[112:115], v[72:75], v[48:51]
  v_mfma_f32_16x16x32_bf16 v[52:55], v[112:115], v[76:79], v[52:55]
  v_mfma_f32_16x16x32_bf16 v[56:59], v[116:119], v[72:75], v[56:59]
  v_mfma_f32_16x16x32_bf16 v[60:63], v[116:119], v[76:79], v[60:63]
  s_waitcnt vmcnt(0)
  v_mul_f32 v22, 0xbfb8aa3b, v22
  v_exp_f32 v22, v22
  s_nop 0
  v_add_f32 v22, 1.0, v22
  v_rcp_f32 v22, v22
  s_nop 0
  v_sub_f32 v21, 1.0, v22
  s_lshl_b32 s62, s48, 13
  v_lshlrev_b32 v17, 4, v1
  v_add_u32 v18, s62, v17
  s_xor_b32 s63, s48, 2
  s_lshl_b32 s63, s63, 13
  v_add_u32 v19, s63, v17
  s_nop 4
  s_cmp_eq_u32 s60, 0
  s_cbranch_scc0 K3_X1
  ds_write_b128 v18, v[28:31] offset:0
  ds_write_b128 v18, v[36:39] offset:1024
  ds_write_b128 v18, v[44:47] offset:2048
  ds_write_b128 v18, v[52:55] offset:3072
  ds_write_b128 v18, v[60:63] offset:4096
  s_waitcnt lgkmcnt(0)
  s_barrier
  ds_read_b128 v[64:67], v19 offset:0
  ds_read_b128 v[68:71], v19 offset:1024
  ds_read_b128 v[72:75], v19 offset:2048
  ds_read_b128 v[76:79], v19 offset:3072
  ds_read_b128 v[80:83], v19 offset:4096
  v_mul_f32 v24, v24, v22
  v_mul_f32 v25, v25, v22
  v_mul_f32 v26, v26, v22
  v_mul_f32 v27, v27, v22
  v_mul_f32 v32, v32, v22
  v_mul_f32 v33, v33, v22
  v_mul_f32 v34, v34, v22
  v_mul_f32 v35, v35, v22
  v_mul_f32 v40, v40, v22
  v_mul_f32 v41, v41, v22
  v_mul_f32 v42, v42, v22
  v_mul_f32 v43, v43, v22
  v_mul_f32 v48, v48, v22
  v_mul_f32 v49, v49, v22
  v_mul_f32 v50, v50, v22
  v_mul_f32 v51, v51, v22
  v_mul_f32 v56, v56, v22
  v_mul_f32 v57, v57, v22
  v_mul_f32 v58, v58, v22
  v_mul_f32 v59, v59, v22
  s_waitcnt lgkmcnt(4)
  v_fma_f32 v24, v64, v21, v24
  v_fma_f32 v25, v65, v21, v25
  v_fma_f32 v26, v66, v21, v26
  v_fma_f32 v27, v67, v21, v27
  v_cvt_pk_bf16_f32 v100, v24, v25
  v_cvt_pk_bf16_f32 v101, v26, v27
  s_waitcnt lgkmcnt(3)
  v_fma_f32 v32, v68, v21, v32
  v_fma_f32 v33, v69, v21, v33
  v_fma_f32 v34, v70, v21, v34
  v_fma_f32 v35, v71, v21, v35
  v_cvt_pk_bf16_f32 v102, v32, v33
  v_cvt_pk_bf16_f32 v103, v34, v35
  s_nop 1
  v_permlane16_swap_b32 v100, v102
  v_permlane16_swap_b32 v101, v103
  s_nop 1
  buffer_store_dwordx4 v[100:103], v9, s[44:47], s68 offen offset:0
  s_waitcnt lgkmcnt(2)
  v_fma_f32 v40, v72, v21, v40
  v_fma_f32 v41, v73, v21, v41
  v_fma_f32 v42, v74, v21, v42
  v_fma_f32 v43, v75, v21, v43
  v_cvt_pk_bf16_f32 v104, v40, v41
  v_cvt_pk_bf16_f32 v105, v42, v43
  s_waitcnt lgkmcnt(1)
  v_fma_f32 v48, v76, v21, v48
  v_fma_f32 v49, v77, v21, v49
  v_fma_f32 v50, v78, v21, v50
  v_fma_f32 v51, v79, v21, v51
  v_cvt_pk_bf16_f32 v106, v48, v49
  v_cvt_pk_bf16_f32 v107, v50, v51
  s_nop 1
  v_permlane16_swap_b32 v104, v106
  v_permlane16_swap_b32 v105, v107
  s_nop 1
  buffer_store_dwordx4 v[104:107], v9, s[44:47], s68 offen offset:64
  s_waitcnt lgkmcnt(0)
  v_fma_f32 v56, v80, v21, v56
  v_fma_f32 v57, v81, v21, v57
  v_fma_f32 v58, v82, v21, v58
  v_fma_f32 v59, v83, v21, v59
  v_cvt_pk_bf16_f32 v108, v56, v57
  v_cvt_pk_bf16_f32 v109, v58, v59
  buffer_store_dwordx2 v[108:109], v23, s[44:47], s68 offen offset:128
  s_endpgm
K3_X1:
  ds_write_b128 v18, v[24:27] offset:0
  ds_write_b128 v18, v[32:35] offset:1024
  ds_write_b128 v18, v[40:43] offset:2048
  ds_write_b128 v18, v[48:51] offset:3072
  ds_write_b128 v18, v[56:59] offset:4096
  s_waitcnt lgkmcnt(0)
  s_barrier
  ds_read_b128 v[64:67], v19 offset:0
  ds_read_b128 v[68:71], v19 offset:1024
  ds_read_b128 v[72:75], v19 offset:2048
  ds_read_b128 v[76:79], v19 offset:3072
  ds_read_b128 v[80:83], v19 offset:4096
  v_mul_f32 v28, v28, v21
  v_mul_f32 v29, v29, v21
  v_mul_f32 v30, v30, v21
  v_mul_f32 v31, v31, v21
  v_mul_f32 v36, v36, v21
  v_mul_f32 v37, v37, v21
  v_mul_f32 v38, v38, v21
  v_mul_f32 v39, v39, v21
  v_mul_f32 v44, v44, v21
  v_mul_f32 v45, v45, v21
  v_mul_f32 v46, v46, v21
  v_mul_f32 v47, v47, v21
  v_mul_f32 v52, v52, v21
  v_mul_f32 v53, v53, v21
  v_mul_f32 v54, v54, v21
  v_mul_f32 v55, v55, v21
  v_mul_f32 v60, v60, v21
  v_mul_f32 v61, v61, v21
  v_mul_f32 v62, v62, v21
  v_mul_f32 v63, v63, v21
  s_waitcnt lgkmcnt(4)
  v_fma_f32 v28, v64, v22, v28
  v_fma_f32 v29, v65, v22, v29
  v_fma_f32 v30, v66, v22, v30
  v_fma_f32 v31, v67, v22, v31
  v_cvt_pk_bf16_f32 v100, v28, v29
  v_cvt_pk_bf16_f32 v101, v30, v31
  s_waitcnt lgkmcnt(3)
  v_fma_f32 v36, v68, v22, v36
  v_fma_f32 v37, v69, v22, v37
  v_fma_f32 v38, v70, v22, v38
  v_fma_f32 v39, v71, v22, v39
  v_cvt_pk_bf16_f32 v102, v36, v37
  v_cvt_pk_bf16_f32 v103, v38, v39
  s_nop 1
  v_permlane16_swap_b32 v100, v102
  v_permlane16_swap_b32 v101, v103
  s_nop 1
  buffer_store_dwordx4 v[100:103], v9, s[44:47], s68 offen offset:0
  s_waitcnt lgkmcnt(2)
  v_fma_f32 v44, v72, v22, v44
  v_fma_f32 v45, v73, v22, v45
  v_fma_f32 v46, v74, v22, v46
  v_fma_f32 v47, v75, v22, v47
  v_cvt_pk_bf16_f32 v104, v44, v45
  v_cvt_pk_bf16_f32 v105, v46, v47
  s_waitcnt lgkmcnt(1)
  v_fma_f32 v52, v76, v22, v52
  v_fma_f32 v53, v77, v22, v53
  v_fma_f32 v54, v78, v22, v54
  v_fma_f32 v55, v79, v22, v55
  v_cvt_pk_bf16_f32 v106, v52, v53
  v_cvt_pk_bf16_f32 v107, v54, v55
  s_nop 1
  v_permlane16_swap_b32 v104, v106
  v_permlane16_swap_b32 v105, v107
  s_nop 1
  buffer_store_dwordx4 v[104:107], v9, s[44:47], s68 offen offset:64
  s_waitcnt lgkmcnt(0)
  v_fma_f32 v60, v80, v22, v60
  v_fma_f32 v61, v81, v22, v61
  v_fma_f32 v62, v82, v22, v62
  v_fma_f32 v63, v83, v22, v63
  v_cvt_pk_bf16_f32 v108, v60, v61
  v_cvt_pk_bf16_f32 v109, v62, v63
  buffer_store_dwordx2 v[108:109], v23, s[44:47], s68 offen offset:128
  s_endpgm
K3_LOADER:
  s_sub_u32 s60, s48, 4
  s_lshr_b32 s61, s60, 1
  s_and_b32 s62, s60, 1
  v_lshrrev_b32 v3, 3, v1
  v_and_b32 v4, 7, v1
  v_xor_b32 v4, v4, v3
  v_lshlrev_b32 v4, 4, v4
  v_mul_u32_u24 v3, 2560, v3
  v_add_u32 v2, v3, v4
  s_lshl_b32 s63, s62, 5
  s_add_u32 s63, s63, s49
  s_mul_i32 s67, s63, 2560
  s_mul_i32 s63, s61, 1280
  s_add_u32 s67, s67, s63
  s_lshl_b32 s64, s60, 12
  s_mul_i32 s65, s60, 5120
  s_add_u32 s65, s65, 16384
  s_mul_i32 s68, s60, 5120
  s_mul_i32 s69, s50, 160
  s_waitcnt lgkmcnt(0)
  s_add_u32 s28, s26, 11862016
  s_addc_u32 s29, s27, 0
  s_and_b32 s29, s29, 0xffff
  s_mov_b32 s30, 5242880
  s_mov_b32 s31, 0x20000
  s_mul_i32 s69, s50, 204800
  s_add_u32 s69, s69, 17104896
  s_add_u32 s32, s26, s69
  s_addc_u32 s33, s27, 0
  s_and_b32 s33, s33, 0xffff
  s_mov_b32 s34, 204800
  s_mov_b32 s35, 0x20000
  s_mov_b32 s66, 0
  s_add_u32 s70, s67, 0
  s_add_u32 s71, s66, s64
  s_add_u32 m0, s71, 0
  s_nop 0
  buffer_load_dwordx4 v2, s[28:31], s70 offen lds
  s_add_u32 s70, s67, 20480
  s_add_u32 s71, s66, s64
  s_add_u32 m0, s71, 1024
  s_nop 0
  buffer_load_dwordx4 v2, s[28:31], s70 offen lds
  s_add_u32 s70, s67, 40960
  s_add_u32 s71, s66, s64
  s_add_u32 m0, s71, 2048
  s_nop 0
  buffer_load_dwordx4 v2, s[28:31], s70 offen lds
  s_add_u32 s70, s67, 61440
  s_add_u32 s71, s66, s64
  s_add_u32 m0, s71, 3072
  s_nop 0
  buffer_load_dwordx4 v2, s[28:31], s70 offen lds
  v_lshlrev_b32 v10, 4, v1
  s_add_u32 m0, s66, s65
  s_add_u32 s70, s68, 4096
  buffer_load_dwordx4 v10, s[32:35], s68 offen offset:0 lds
  buffer_load_dwordx4 v10, s[32:35], s68 offen offset:1024 lds
  buffer_load_dwordx4 v10, s[32:35], s68 offen offset:2048 lds
  buffer_load_dwordx4 v10, s[32:35], s68 offen offset:3072 lds
  s_add_u32 m0, m0, 4096
  s_nop 0
  buffer_load_dwordx4 v10, s[32:35], s70 offen lds
  s_add_u32 s67, s67, 128
  s_add_u32 s68, s68, 20480
  s_add_u32 s66, s66, 36864
  s_cmp_eq_u32 s66, 147456
  s_cselect_b32 s66, 0, s66
  s_add_u32 s70, s67, 0
  s_add_u32 s71, s66, s64
  s_add_u32 m0, s71, 0
  s_nop 0
  buffer_load_dwordx4 v2, s[28:31], s70 offen lds
  s_add_u32 s70, s67, 20480
  s_add_u32 s71, s66, s64
  s_add_u32 m0, s71, 1024
  s_nop 0
  buffer_load_dwordx4 v2, s[28:31], s70 offen lds
  s_add_u32 s70, s67, 40960
  s_add_u32 s71, s66, s64
  s_add_u32 m0, s71, 2048
  s_nop 0
  buffer_load_dwordx4 v2, s[28:31], s70 offen lds
  s_add_u32 s70, s67, 61440
  s_add_u32 s71, s66, s64
  s_add_u32 m0, s71, 3072
  s_nop 0
  buffer_load_dwordx4 v2, s[28:31], s70 offen lds
  s_add_u32 m0, s66, s65
  s_add_u32 s70, s68, 4096
  buffer_load_dwordx4 v10, s[32:35], s68 offen offset:0 lds
  buffer_load_dwordx4 v10, s[32:35], s68 offen offset:1024 lds
  buffer_load_dwordx4 v10, s[32:35], s68 offen offset:2048 lds
  buffer_load_dwordx4 v10, s[32:35], s68 offen offset:3072 lds
  s_add_u32 m0, m0, 4096
  s_nop 0
  buffer_load_dwordx4 v10, s[32:35], s70 offen lds
  s_add_u32 s67, s67, 128
  s_add_u32 s68, s68, 20480
  s_add_u32 s66, s66, 36864
  s_cmp_eq_u32 s66, 147456
  s_cselect_b32 s66, 0, s66
  s_waitcnt vmcnt(9)
  s_barrier
  s_mov_b32 s72, 0
K3_LDP:
  s_add_u32 s70, s67, 0
  s_add_u32 s71, s66, s64
  s_add_u32 m0, s71, 0
  s_nop 0
  buffer_load_dwordx4 v2, s[28:31], s70 offen lds
  s_add_u32 s70, s67, 20480
  s_add_u32 s71, s66, s64
  s_add_u32 m0, s71, 1024
  s_nop 0
  buffer_load_dwordx4 v2, s[28:31], s70 offen lds
  s_add_u32 s70, s67, 40960
  s_add_u32 s71, s66, s64
  s_add_u32 m0, s71, 2048
  s_nop 0
  buffer_load_dwordx4 v2, s[28:31], s70 offen lds
  s_add_u32 s70, s67, 61440
  s_add_u32 s71, s66, s64
  s_add_u32 m0, s71, 3072
  s_nop 0
  buffer_load_dwordx4 v2, s[28:31], s70 offen lds
  s_add_u32 m0, s66, s65
  s_add_u32 s70, s68, 4096
  buffer_load_dwordx4 v10, s[32:35], s68 offen offset:0 lds
  buffer_load_dwordx4 v10, s[32:35], s68 offen offset:1024 lds
  buffer_load_dwordx4 v10, s[32:35], s68 offen offset:2048 lds
  buffer_load_dwordx4 v10, s[32:35], s68 offen offset:3072 lds
  s_add_u32 m0, m0, 4096
  s_nop 0
  buffer_load_dwordx4 v10, s[32:35], s70 offen lds
  s_add_u32 s67, s67, 128
  s_add_u32 s68, s68, 20480
  s_add_u32 s66, s66, 36864
  s_cmp_eq_u32 s66, 147456
  s_cselect_b32 s66, 0, s66
  s_add_u32 s72, s72, 1
  s_cmp_lt_u32 s72, 2
  s_cbranch_scc1 K3_LDP
  s_mov_b32 s72, 1
K3_LDM:
  s_waitcnt vmcnt(18)
  s_barrier
  s_add_u32 s70, s67, 0
  s_add_u32 s71, s66, s64
  s_add_u32 m0, s71, 0
  s_nop 0
  buffer_load_dwordx4 v2, s[28:31], s70 offen lds
  s_add_u32 s70, s67, 20480
  s_add_u32 s71, s66, s64
  s_add_u32 m0, s71, 1024
  s_nop 0
  buffer_load_dwordx4 v2, s[28:31], s70 offen lds
  s_add_u32 s70, s67, 40960
  s_add_u32 s71, s66, s64
  s_add_u32 m0, s71, 2048
  s_nop 0
  buffer_load_dwordx4 v2, s[28:31], s70 offen lds
  s_add_u32 s70, s67, 61440
  s_add_u32 s71, s66, s64
  s_add_u32 m0, s71, 3072
  s_nop 0
  buffer_load_dwordx4 v2, s[28:31], s70 offen lds
  s_add_u32 m0, s66, s65
  s_add_u32 s70, s68, 4096
  buffer_load_dwordx4 v10, s[32:35], s68 offen offset:0 lds
  buffer_load_dwordx4 v10, s[32:35], s68 offen offset:1024 lds
  buffer_load_dwordx4 v10, s[32:35], s68 offen offset:2048 lds
  buffer_load_dwordx4 v10, s[32:35], s68 offen offset:3072 lds
  s_add_u32 m0, m0, 4096
  s_nop 0
  buffer_load_dwordx4 v10, s[32:35], s70 offen lds
  s_add_u32 s67, s67, 128
  s_add_u32 s68, s68, 20480
  s_add_u32 s66, s66, 36864
  s_cmp_eq_u32 s66, 147456
  s_cselect_b32 s66, 0, s66
  s_add_u32 s72, s72, 1
  s_cmp_lt_u32 s72, 7
  s_cbranch_scc1 K3_LDM
  s_waitcnt vmcnt(18)
  s_barrier
  s_waitcnt vmcnt(9)
  s_barrier
  s_waitcnt vmcnt(0)
  s_barrier
  s_endpgm
K3_END:
  s_endpgm
.section .rodata,"a"
.p2align 6
.amdhsa_kernel k1_kernel
  .amdhsa_next_free_vgpr 192
  .amdhsa_next_free_sgpr 102
  .amdhsa_accum_offset 192
  .amdhsa_group_segment_fixed_size 0
  .amdhsa_kernarg_size 96
  .amdhsa_user_sgpr_count 2
  .amdhsa_user_sgpr_kernarg_segment_ptr 1
  .amdhsa_system_sgpr_workgroup_id_x 1
  .amdhsa_float_denorm_mode_32 3
.end_amdhsa_kernel
.p2align 6
.amdhsa_kernel k2_kernel
  .amdhsa_next_free_vgpr 168
  .amdhsa_next_free_sgpr 102
  .amdhsa_accum_offset 168
  .amdhsa_group_segment_fixed_size 0
  .amdhsa_kernarg_size 96
  .amdhsa_user_sgpr_count 2
  .amdhsa_user_sgpr_kernarg_segment_ptr 1
  .amdhsa_system_sgpr_workgroup_id_x 1
  .amdhsa_float_denorm_mode_32 3
.end_amdhsa_kernel
.p2align 6
.amdhsa_kernel k3_kernel
  .amdhsa_next_free_vgpr 120
  .amdhsa_next_free_sgpr 102
  .amdhsa_accum_offset 120
  .amdhsa_group_segment_fixed_size 0
  .amdhsa_kernarg_size 96
  .amdhsa_user_sgpr_count 2
  .amdhsa_user_sgpr_kernarg_segment_ptr 1
  .amdhsa_system_sgpr_workgroup_id_x 1
  .amdhsa_float_denorm_mode_32 3
.end_amdhsa_kernel
```
